```python
import torch

def _softmax(x, axis=-1):
    return torch.softmax(x, dim=axis)
def _gelu(x):
    return torch.nn.functional.gelu(x, approximate="tanh")
def _silu(x):
    return torch.nn.functional.silu(x)
def _sigmoid(x):
    return torch.sigmoid(x)
def _layernorm(x, axis=-1, eps=1e-5):
    m = x.mean(dim=axis, keepdim=True)
    v = x.var(dim=axis, keepdim=True, unbiased=False)
    return (x - m) / torch.sqrt(v + eps)
def _scatter_add(tgt, idx, src, axis=0):
    return tgt.clone().index_add_(axis, idx, src)
def _segment_sum(src, seg, n):
    out = torch.zeros((n,) + src.shape[1:], dtype=src.dtype)
    return out.index_add_(0, seg, src)
def _pad(x, pw):
    flat = tuple(v for pair in reversed(pw) for v in pair)
    return torch.nn.functional.pad(x, flat)

kernel_name = 'interleave_layers__compressed_kv_cla__glu_gated_geglu__decode'

def setup_inputs():

    _w = (lambda a: (lambda t: t.to(torch.bfloat16) if t.is_floating_point() else t)(torch.as_tensor(a)))
    def _A_setup():
        B, H, Sq, Sk, D, M = 2, 32, 1, 4096, 128, 512
        Dc = 4 * D
        return {
            "x": _w((lambda *s: torch.randn(*s, dtype=torch.bfloat16) * 0.05)(B, Sq, M)),
            "c_kv": _w((lambda *s: torch.randn(*s, dtype=torch.bfloat16) * 0.8)(B, Sk, Dc)),
            "w_q": _w((lambda *s: torch.randn(*s, dtype=torch.bfloat16) * 1.6)(M, H, D) * (M ** -0.5)),
            "w_uk": _w((lambda *s: torch.randn(*s, dtype=torch.bfloat16) * 1.6)(Dc, H, D) * (Dc ** -0.5)),
            "w_uv": _w((lambda *s: torch.randn(*s, dtype=torch.bfloat16) * 0.8)(Dc, H, D) * (Dc ** -0.5)),
            "w_o": _w((lambda *s: torch.randn(*s, dtype=torch.bfloat16) * 0.8)(H, D, M) * ((H * D) ** -0.5)),
        }
    _A_in = _A_setup()

    def _B_setup():
        B, S, Dm, Df = 2, 1, 512, 1376
        return {
            "x": _w((lambda *s: torch.randn(*s, dtype=torch.bfloat16) * 0.05)(B, S, Dm)),
            "w_gate": _w((lambda *s: torch.randn(*s, dtype=torch.bfloat16) * 0.4)(Dm, Df) * (Dm ** -0.5)),
            "w_up": _w((lambda *s: torch.randn(*s, dtype=torch.bfloat16) * 0.4)(Dm, Df) * (Dm ** -0.5)),
            "w_down": _w((lambda *s: torch.randn(*s, dtype=torch.bfloat16) * 0.4)(Df, Dm) * (Df ** -0.5)),
        }
    _B_in = _B_setup()

    return {
        "A_x": _A_in["x"],
        "A_c_kv": _A_in["c_kv"],
        "A_w_q": _A_in["w_q"],
        "A_w_uk": _A_in["w_uk"],
        "A_w_uv": _A_in["w_uv"],
        "A_w_o": _A_in["w_o"],
        "B_x": _B_in["x"],
        "B_w_gate": _B_in["w_gate"],
        "B_w_up": _B_in["w_up"],
        "B_w_down": _B_in["w_down"],
    }

def reference(A_x, A_c_kv, A_w_q, A_w_uk, A_w_uv, A_w_o, B_x, B_w_gate, B_w_up, B_w_down):
    def _A_ref(x, c_kv, w_q, w_uk, w_uv, w_o):
        B, Sq, M = x.shape[0], x.shape[1], x.shape[2]
        Sk = c_kv.shape[1]
        H, D = w_q.shape[1], w_q.shape[2]
        q = torch.einsum("bqm,mhd->bhqd", x, w_q)
        k = torch.einsum("bkc,chd->bhkd", c_kv, w_uk)
        v = torch.einsum("bkc,chd->bhkd", c_kv, w_uv)
        scores = torch.einsum("bhqd,bhkd->bhqk", q, k) * (D ** -0.5)
        off = Sk - Sq
        qi = torch.arange(Sq)[:, None]
        kj = torch.arange(Sk)[None, :]
        cmask = kj <= (qi + off)
        scores = torch.where(cmask[None, None], scores, -1e9)
        p = _softmax(scores, axis=-1)
        ctx = torch.einsum("bhqk,bhkd->bhqd", p, v)
        return torch.einsum("bhqd,hdm->bqm", ctx, w_o)

    def _B_ref(x, w_gate, w_up, w_down):
        g = torch.einsum("bsd,df->bsf", x, w_gate)
        u = torch.einsum("bsd,df->bsf", x, w_up)
        h = _gelu(g) * u
        return torch.einsum("bsf,fd->bsd", h, w_down)

    x = A_x
    x = x + _A_ref(_layernorm(x, axis=-1), A_c_kv, A_w_q, A_w_uk, A_w_uv, A_w_o)
    x = x + _B_ref(_layernorm(x, axis=-1), B_w_gate, B_w_up, B_w_down)
    x = x + _A_ref(_layernorm(x, axis=-1), A_c_kv, A_w_q, A_w_uk, A_w_uv, A_w_o)
    x = x + _B_ref(_layernorm(x, axis=-1), B_w_gate, B_w_up, B_w_down)
    return x
```

```asm
; @launch grid=(256,1,1) block=(512,1,1) lds=160896
.amdgcn_target "amdgcn-amd-amdhsa--gfx950"
.text
.p2align 12
.fill 832, 4, 0xbf800000
.globl interleave_layers__compressed_kv_cla__glu_gated_geglu__decode_kernel
.p2align 8
.type interleave_layers__compressed_kv_cla__glu_gated_geglu__decode_kernel,@function
interleave_layers__compressed_kv_cla__glu_gated_geglu__decode_kernel:
s_cmp_ge_u32 s2, 256
s_cbranch_scc1 L_end
s_load_dwordx2 s[4:5], s[0:1], 96
s_lshr_b32 s53, s2, 3
s_cmp_ge_u32 s53, 16
s_cbranch_scc1 L_roleB
s_load_dwordx2 s[16:17], s[0:1], 16
s_load_dwordx2 s[20:21], s[0:1], 24
s_load_dwordx2 s[8:9], s[0:1], 0
v_lshrrev_b32 v6, 6, v0
v_and_b32 v2, 15, v0
s_and_b32 s52, s2, 7
v_readfirstlane_b32 s54, v6
v_bfe_u32 v3, v0, 4, 2
v_lshlrev_b32 v7, 4, v2
s_mov_b32 s18, 4194304
s_mov_b32 s19, 0x20000
s_mov_b32 s22, 4194304
s_mov_b32 s23, 0x20000
s_and_b32 s51, s53, 3
s_lshl_b32 s68, s52, 2
s_add_u32 s68, s68, s51
s_lshr_b32 s69, s53, 2
s_mul_i32 s67, s54, 8448
s_cmp_ge_u32 s54, 4
s_cbranch_scc1 L_jn_1
s_lshl_b32 s64, s53, 8
s_add_u32 s64, s64, s52
s_lshl_b32 s64, s64, 2
s_add_u32 s64, s64, s54
s_lshl_b32 s64, s64, 8
v_lshl_add_u32 v9, v3, 15, v7
v_add_u32 v9, s64, v9
v_bfe_u32 v10, v2, 2, 1
v_lshlrev_b32 v6, 10, v10
v_lshl_add_u32 v6, v3, 2, v6
s_lshl_b32 s65, s53, 6
v_add_u32 v174, s65, v6
s_mov_b32 s10, 2048
s_mov_b32 s11, 0x20000
s_waitcnt lgkmcnt(0)
buffer_load_dword v24, v174, s[8:11], 0 offen offset:0
buffer_load_dword v25, v174, s[8:11], 0 offen offset:32
buffer_load_dword v26, v174, s[8:11], 0 offen offset:16
buffer_load_dword v27, v174, s[8:11], 0 offen offset:48
s_mov_b32 s64, 0
s_add_u32 m0, s67, 0
s_nop 0
buffer_load_dwordx4 v9, s[16:19], s64 offen lds
s_mov_b32 s64, 8192
s_add_u32 m0, s67, 1056
s_nop 0
buffer_load_dwordx4 v9, s[16:19], s64 offen lds
s_mov_b32 s64, 16384
s_add_u32 m0, s67, 2112
s_nop 0
buffer_load_dwordx4 v9, s[16:19], s64 offen lds
s_mov_b32 s64, 24576
s_add_u32 m0, s67, 3168
s_nop 0
buffer_load_dwordx4 v9, s[16:19], s64 offen lds
s_mov_b32 s64, 131072
s_add_u32 m0, s67, 4224
s_nop 0
buffer_load_dwordx4 v9, s[16:19], s64 offen lds
s_mov_b32 s64, 139264
s_add_u32 m0, s67, 5280
s_nop 0
buffer_load_dwordx4 v9, s[16:19], s64 offen lds
s_mov_b32 s64, 147456
s_add_u32 m0, s67, 6336
s_nop 0
buffer_load_dwordx4 v9, s[16:19], s64 offen lds
s_mov_b32 s64, 155648
s_add_u32 m0, s67, 7392
s_nop 0
buffer_load_dwordx4 v9, s[16:19], s64 offen lds
L_jn_1:
s_waitcnt lgkmcnt(0)
s_load_dword s55, s[4:5], 0
s_load_dwordx2 s[24:25], s[0:1], 32
s_load_dwordx2 s[28:29], s[0:1], 40
s_load_dwordx2 s[44:45], s[0:1], 80
s_mov_b32 s6, 268435456
s_mov_b32 s7, 0x20000
v_and_b32 v1, 63, v0
v_mov_b32 v13, 2147483392
s_mov_b32 s56, 0x00010001
s_movk_i32 s57, 0xff
s_mov_b32 s58, 0x07060302
s_mov_b32 s59, 4194304
s_getreg_b32 s61, hwreg(HW_REG_XCC_ID)
s_and_b32 s61, s61, 15
s_lshl_b32 s62, s52, 4
s_add_u32 s62, s62, s53
s_mov_b32 s60, 0
v_lshlrev_b32 v7, 4, v1
v_bfe_u32 v10, v2, 2, 1
v_lshlrev_b32 v11, 4, v3
v_bfe_u32 v14, v1, 2, 2
v_and_b32 v15, 3, v1
v_and_b32 v6, 1, v14
v_lshlrev_b32 v6, 2, v6
v_lshrrev_b32 v8, 1, v14
v_add_u32 v6, v6, v8
v_and_b32 v8, 1, v3
v_lshl_add_u32 v6, v8, 1, v6
v_mul_u32_u24 v6, 1056, v6
v_lshrrev_b32 v8, 1, v3
v_lshl_add_u32 v6, v8, 8, v6
v_lshl_add_u32 v6, v15, 3, v6
v_add_u32 v31, s67, v6
s_lshl_b32 s64, s62, 2
s_add_u32 s64, s64, s54
s_lshl_b32 s65, s64, 10
s_add_u32 s65, s65, 2097152
v_add_u32 v6, s65, v7
v_cmp_gt_u32 vcc, 32, v1
s_lshl_b32 s65, s64, 9
s_add_u32 s65, s65, 3145216
v_cndmask_b32 v177, v13, v6, vcc
v_add_u32 v6, s65, v7
s_and_b32 s64, s68, 24
s_add_u32 s64, s64, s68
s_lshl_b32 s64, s64, 2
s_add_u32 s64, s64, s69
s_lshl_b32 s65, s64, 1
s_and_b32 s66, s54, 1
s_add_u32 s65, s65, s66
s_lshl_b32 s65, s65, 7
v_lshlrev_b32 v8, 16, v3
v_lshl_add_u32 v8, v2, 3, v8
v_add_u32 v8, s65, v8
v_cndmask_b32 v184, v13, v8, vcc
v_cmp_eq_u32 vcc, 2, v3
s_nop 1
v_cndmask_b32 v176, v177, v6, vcc
v_add_u32 v6, 256, v176
v_add_u32 v8, 512, v176
v_cndmask_b32 v207, v8, v6, vcc
v_lshrrev_b32 v6, 3, v1
v_sub_u32 v8, v1, v6
v_add_u32 v8, 3, v8
s_mov_b32 vcc_lo, 0x01100101
s_mov_b32 vcc_hi, 0
v_cndmask_b32 v6, v8, v6, vcc
s_lshl_b32 s64, s62, 7
v_lshl_add_u32 v6, v6, 3, s64
s_cmp_eq_u32 s54, 0
s_cselect_b32 vcc_lo, 0x01103fff, 0
v_cndmask_b32 v181, v13, v6, vcc
v_lshrrev_b32 v8, 3, v1
v_and_b32 v9, 7, v1
v_lshlrev_b32 v9, 4, v9
s_lshl_b32 s64, s52, 6
s_add_u32 s64, s64, s51
s_lshl_b32 s65, s64, 3
s_add_u32 s65, s65, s54
s_lshl_b32 s65, s65, 7
v_lshl_add_u32 v6, v8, 12, v9
v_add_u32 v178, s65, v6
s_lshr_b32 s66, s54, 2
s_lshl_b32 s64, s64, 1
s_add_u32 s64, s64, s66
s_lshl_b32 s64, s64, 1
s_and_b32 s63, s54, 1
s_add_u32 s64, s64, s63
s_lshl_b32 s64, s64, 7
s_add_u32 s64, s64, 3145728
v_lshl_add_u32 v6, v8, 11, v9
v_add_u32 v179, s64, v6
s_bfe_u32 s65, s54, 0x10001
s_lshl_b32 s64, s52, 7
s_add_u32 s64, s64, s65
s_lshl_b32 s64, s64, 4
v_lshlrev_b32 v6, 7, v2
v_add_u32 v180, s64, v6
v_and_b32 v6, 1, v2
v_mul_u32_u24 v108, 0xaaaa, v6
v_add_u32 v108, 0x4444, v108
s_lshl_b32 s64, s65, 2
s_add_u32 s64, s64, s66
s_lshl_b32 s64, s64, 3
s_add_u32 s64, s64, s63
s_lshl_b32 s64, s64, 3
s_add_u32 s64, s64, 134400
v_bfe_u32 v8, v1, 1, 1
v_lshl_add_u32 v8, v8, 7, v11
v_lshl_add_u32 v8, v6, 1, v8
v_and_b32 v12, 4, v1
v_add3_u32 v182, v8, v12, s64
v_lshl_add_u32 v6, v6, 7, v11
v_lshl_add_u32 v6, v10, 8, v6
v_add_u32 v183, 134400, v6
v_mov_b32 v6, 0x3f803f80
v_cmp_eq_u32 vcc, 8, v2
v_mov_b32 v8, 0
s_nop 0
v_cndmask_b32 v173, v8, v6, vcc
s_lshl_b32 s64, s53, 9
v_xor_b32 v6, 0, v0
v_add_u32 v6, s64, v6
s_lshl_b32 s64, s52, 7
s_add_u32 s64, s64, 16384
v_lshl_add_u32 v8, v6, 13, s64
v_cmp_gt_u32 vcc, 2, v6
s_nop 1
v_cndmask_b32 v205, v13, v8, vcc
v_and_b32 v6, 7, v0
v_lshlrev_b32 v6, 7, v6
v_add_u32 v206, 16384, v6
v_mov_b32 v30, v13
s_mov_b32 s74, 0
s_cmp_lt_u32 s54, 4
s_cbranch_scc1 L_k_2
s_cmp_lg_u32 s54, 4
s_cbranch_scc1 L_k_3
s_lshl_b32 s64, s62, 12
s_add_u32 s64, s64, 2097152
s_lshl_b32 s65, s62, 11
s_add_u32 s65, s65, 3141632
s_lshl_b32 s66, s62, 7
s_add_u32 s66, s66, 3670016
v_lshlrev_b32 v6, 7, v1
v_add_u32 v8, s64, v6
v_add_u32 v6, s65, v6
v_cmp_gt_u32 vcc, 32, v1
s_nop 1
v_cndmask_b32 v6, v6, v8, vcc
v_mov_b32 v8, s66
v_cmp_gt_u32 vcc, 48, v1
s_nop 1
v_cndmask_b32 v6, v8, v6, vcc
buffer_load_dword v28, v6, s[4:7], 0 offen
L_k_3:
s_cmp_ge_u32 s54, 6
s_cbranch_scc1 L_k_2
s_lshl_b32 s64, s69, 1
s_add_u32 s64, s64, s54
s_sub_u32 s64, s64, 4
s_lshl_b32 s64, s64, 11
s_add_u32 s64, s64, s68
s_lshl_b32 s64, s64, 8
v_lshlrev_b32 v9, 4, v2
v_lshl_add_u32 v9, v3, 13, v9
v_add_u32 v9, s64, v9
s_lshl_b32 s67, s67, 1
s_sub_u32 s67, s67, 33536
v_mov_b32 v30, v9
s_mov_b32 s74, s67
L_k_2:
s_waitcnt lgkmcnt(0)
s_add_u32 s55, s55, 1
s_cselect_b32 s55, 2, s55
v_mov_b32 v4, s55
v_lshrrev_b32 v208, 8, v4
s_bfe_u32 s48, s55, 524296
v_lshrrev_b32 v209, 16, v4
s_bfe_u32 s49, s55, 524304
v_lshrrev_b32 v210, 24, v4
s_bfe_u32 s50, s55, 524312
s_and_b32 s76, s55, 0xff
s_mov_b32 s77, 0xfffefffe
v_and_b32 v6, 7, v2
v_lshlrev_b32 v6, 2, v6
v_lshrrev_b32 v6, v6, v4
v_bfe_u32 v252, v6, 0, 2
v_lshl_or_b32 v252, v252, 15, v252
v_and_b32 v252, s56, v252
v_bfe_u32 v253, v6, 2, 2
v_lshl_or_b32 v253, v253, 15, v253
v_and_b32 v253, s56, v253
s_cmp_ge_u32 s54, 4
s_cbranch_scc1 L_k_4
s_waitcnt vmcnt(0)
ds_read_b64_tr_b16 v[32:33], v31 offset:0
ds_read_b64_tr_b16 v[34:35], v31 offset:512
ds_read_b64_tr_b16 v[36:37], v31 offset:32
ds_read_b64_tr_b16 v[38:39], v31 offset:544
ds_read_b64_tr_b16 v[40:41], v31 offset:64
ds_read_b64_tr_b16 v[42:43], v31 offset:576
ds_read_b64_tr_b16 v[44:45], v31 offset:96
ds_read_b64_tr_b16 v[46:47], v31 offset:608
ds_read_b64_tr_b16 v[48:49], v31 offset:128
ds_read_b64_tr_b16 v[50:51], v31 offset:640
ds_read_b64_tr_b16 v[52:53], v31 offset:160
ds_read_b64_tr_b16 v[54:55], v31 offset:672
ds_read_b64_tr_b16 v[56:57], v31 offset:192
ds_read_b64_tr_b16 v[58:59], v31 offset:704
s_waitcnt lgkmcnt(8)
ds_read_b64_tr_b16 v[60:61], v31 offset:224
ds_read_b64_tr_b16 v[62:63], v31 offset:736
s_mov_b32 s64, 0x05040100
v_mov_b32 v6, 0x3f803f80
v_cmp_eq_u32 vcc, 8, v2
v_perm_b32 v20, v25, v24, s64
v_perm_b32 v21, v25, v24, s58
v_perm_b32 v22, v27, v26, s64
v_perm_b32 v23, v27, v26, s58
v_cndmask_b32 v160, v20, v6, vcc
v_cndmask_b32 v161, v21, v6, vcc
v_cndmask_b32 v162, v22, v6, vcc
v_cndmask_b32 v163, v23, v6, vcc
s_waitcnt lgkmcnt(0)
s_branch L_k_5
L_k_4:
s_cmp_ge_u32 s54, 6
s_cbranch_scc1 L_k_5
L_k_5:
s_lshl_b32 s64, s2, 3
s_add_u32 s64, s64, s54
s_cmp_lg_u32 s64, 7
s_cbranch_scc1 L_nd_6
s_sleep 26
s_mov_b32 s64, 0
s_mov_b32 s65, 0
s_xor_b32 s66, s55, 0x80000000
s_movk_i32 s67, 1024
L_vt_7:
s_load_dwordx16 s[32:47], s[4:5], s67
s_add_u32 s67, s67, 128
s_waitcnt lgkmcnt(0)
s_cmp_eq_u32 s32, s55
s_addc_u32 s64, s64, 0
s_cmp_eq_u32 s32, s66
s_addc_u32 s65, s65, 0
s_cmp_eq_u32 s33, s55
s_addc_u32 s64, s64, 0
s_cmp_eq_u32 s33, s66
s_addc_u32 s65, s65, 0
s_cmp_eq_u32 s34, s55
s_addc_u32 s64, s64, 0
s_cmp_eq_u32 s34, s66
s_addc_u32 s65, s65, 0
s_cmp_eq_u32 s35, s55
s_addc_u32 s64, s64, 0
s_cmp_eq_u32 s35, s66
s_addc_u32 s65, s65, 0
s_cmp_eq_u32 s36, s55
s_addc_u32 s64, s64, 0
s_cmp_eq_u32 s36, s66
s_addc_u32 s65, s65, 0
s_cmp_eq_u32 s37, s55
s_addc_u32 s64, s64, 0
s_cmp_eq_u32 s37, s66
s_addc_u32 s65, s65, 0
s_cmp_eq_u32 s38, s55
s_addc_u32 s64, s64, 0
s_cmp_eq_u32 s38, s66
s_addc_u32 s65, s65, 0
s_cmp_eq_u32 s39, s55
s_addc_u32 s64, s64, 0
s_cmp_eq_u32 s39, s66
s_addc_u32 s65, s65, 0
s_cmp_eq_u32 s40, s55
s_addc_u32 s64, s64, 0
s_cmp_eq_u32 s40, s66
s_addc_u32 s65, s65, 0
s_cmp_eq_u32 s41, s55
s_addc_u32 s64, s64, 0
s_cmp_eq_u32 s41, s66
s_addc_u32 s65, s65, 0
s_cmp_eq_u32 s42, s55
s_addc_u32 s64, s64, 0
s_cmp_eq_u32 s42, s66
s_addc_u32 s65, s65, 0
s_cmp_eq_u32 s43, s55
s_addc_u32 s64, s64, 0
s_cmp_eq_u32 s43, s66
s_addc_u32 s65, s65, 0
s_cmp_eq_u32 s44, s55
s_addc_u32 s64, s64, 0
s_cmp_eq_u32 s44, s66
s_addc_u32 s65, s65, 0
s_cmp_eq_u32 s45, s55
s_addc_u32 s64, s64, 0
s_cmp_eq_u32 s45, s66
s_addc_u32 s65, s65, 0
s_cmp_eq_u32 s46, s55
s_addc_u32 s64, s64, 0
s_cmp_eq_u32 s46, s66
s_addc_u32 s65, s65, 0
s_cmp_eq_u32 s47, s55
s_addc_u32 s64, s64, 0
s_cmp_eq_u32 s47, s66
s_addc_u32 s65, s65, 0
s_sub_i32 s63, s64, s65
s_abs_i32 s63, s63
s_cmp_ge_u32 s63, 5
s_cbranch_scc1 L_vz_8
s_cmp_lt_u32 s67, 1536
s_cbranch_scc1 L_vt_7
L_vz_8:
s_load_dwordx2 s[44:45], s[0:1], 80
s_cmp_gt_u32 s65, s64
s_cselect_b32 s64, 8, 0
s_and_b32 s65, s61, 7
s_or_b32 s64, s64, s65
v_mov_b32 v9, s64
v_mov_b32 v8, v4
v_mov_b32 v6, 128
s_mov_b64 exec, 1
buffer_store_dwordx2 v[8:9], v6, s[4:7], 0 offen sc1
s_mov_b64 exec, -1
s_waitcnt lgkmcnt(0)
s_mov_b32 s46, 2048
s_mov_b32 s47, 0x20000
L_nd_6:
s_cmp_ge_u32 s54, 4
s_cbranch_scc1 L_k_9
v_mfma_f32_16x16x32_bf16 v[228:231], v[160:163], v[160:163], 0
v_mfma_f32_16x16x32_bf16 v[8:11], v[160:163], v[32:35], 0
v_mfma_f32_16x16x32_bf16 v[12:15], v[160:163], v[36:39], 0
v_mfma_f32_16x16x32_bf16 v[16:19], v[160:163], v[40:43], 0
v_mfma_f32_16x16x32_bf16 v[20:23], v[160:163], v[44:47], 0
v_mfma_f32_16x16x32_bf16 v[212:215], v[160:163], v[48:51], 0
v_mfma_f32_16x16x32_bf16 v[216:219], v[160:163], v[52:55], 0
v_mfma_f32_16x16x32_bf16 v[220:223], v[160:163], v[56:59], 0
v_mfma_f32_16x16x32_bf16 v[224:227], v[160:163], v[60:63], 0
s_mov_b32 s65, 0
s_mov_b32 s66, 3670016
v_mov_b32 v229, v4
v_mov_b32 v6, s61
v_bfi_b32 v228, 15, v6, v228
v_bfi_b32 v232, s57, v4, v8
v_bfi_b32 v233, s57, v208, v12
v_bfi_b32 v234, s57, v209, v16
v_bfi_b32 v235, s57, v210, v20
v_bfi_b32 v236, s57, v4, v212
v_bfi_b32 v237, s57, v208, v216
v_bfi_b32 v238, s57, v209, v220
v_bfi_b32 v239, s57, v210, v224
buffer_store_dwordx4 v[232:235], v176, s[4:7], 0 offen
buffer_store_dwordx4 v[236:239], v207, s[4:7], 0 offen
buffer_store_dwordx2 v[228:229], v181, s[4:7], s66 offen
L_k_9:
s_mov_b32 s64, 2097152
s_mov_b32 s65, 2129920
s_mov_b32 s66, 3670016
s_movk_i32 s67, 16384
s_movk_i32 s63, 24
s_mov_b32 s73, 0
s_branch L_i0r_11
L_i0m_12:
s_mov_b64 exec, 0xffff
buffer_load_dwordx4 v[16:19], v180, s[4:7], s66 offen sc1
s_mov_b64 exec, -1
buffer_load_dwordx4 v[8:11], v178, s[4:7], s64 offen sc1
buffer_load_dwordx4 v[12:15], v178, s[4:7], s65 offen sc1
buffer_load_dwordx4 v[20:23], v179, s[4:7], 0 offen sc1
buffer_load_dwordx4 v[24:27], v179, s[4:7], s67 offen sc1
s_and_b32 s72, s54, 6
s_xor_b32 s72, s72, 4
s_or_b32 s72, s72, s73
s_cbranch_scc1 L_wk_13
s_mov_b32 s73, 1
s_mov_b32 s75, 0
s_add_u32 m0, s74, 0
s_nop 0
buffer_load_dwordx4 v30, s[20:23], s75 offen lds
s_mov_b32 s75, 32768
s_add_u32 m0, s74, 1056
s_nop 0
buffer_load_dwordx4 v30, s[20:23], s75 offen lds
s_mov_b32 s75, 65536
s_add_u32 m0, s74, 2112
s_nop 0
buffer_load_dwordx4 v30, s[20:23], s75 offen lds
s_mov_b32 s75, 98304
s_add_u32 m0, s74, 3168
s_nop 0
buffer_load_dwordx4 v30, s[20:23], s75 offen lds
s_mov_b32 s75, 131072
s_add_u32 m0, s74, 4224
s_nop 0
buffer_load_dwordx4 v30, s[20:23], s75 offen lds
s_mov_b32 s75, 163840
s_add_u32 m0, s74, 5280
s_nop 0
buffer_load_dwordx4 v30, s[20:23], s75 offen lds
s_mov_b32 s75, 196608
s_add_u32 m0, s74, 6336
s_nop 0
buffer_load_dwordx4 v30, s[20:23], s75 offen lds
s_mov_b32 s75, 229376
s_add_u32 m0, s74, 7392
s_nop 0
buffer_load_dwordx4 v30, s[20:23], s75 offen lds
s_mov_b32 s75, 262144
s_add_u32 m0, s74, 8448
s_nop 0
buffer_load_dwordx4 v30, s[20:23], s75 offen lds
s_mov_b32 s75, 294912
s_add_u32 m0, s74, 9504
s_nop 0
buffer_load_dwordx4 v30, s[20:23], s75 offen lds
s_mov_b32 s75, 327680
s_add_u32 m0, s74, 10560
s_nop 0
buffer_load_dwordx4 v30, s[20:23], s75 offen lds
s_mov_b32 s75, 360448
s_add_u32 m0, s74, 11616
s_nop 0
buffer_load_dwordx4 v30, s[20:23], s75 offen lds
s_mov_b32 s75, 393216
s_add_u32 m0, s74, 12672
s_nop 0
buffer_load_dwordx4 v30, s[20:23], s75 offen lds
s_mov_b32 s75, 425984
s_add_u32 m0, s74, 13728
s_nop 0
buffer_load_dwordx4 v30, s[20:23], s75 offen lds
s_mov_b32 s75, 458752
s_add_u32 m0, s74, 14784
s_nop 0
buffer_load_dwordx4 v30, s[20:23], s75 offen lds
s_mov_b32 s75, 491520
s_add_u32 m0, s74, 15840
s_nop 0
buffer_load_dwordx4 v30, s[20:23], s75 offen lds
s_waitcnt vmcnt(20)
s_branch L_wl_14
L_wk_13:
s_mov_b32 s73, 2
s_waitcnt vmcnt(4)
L_wl_14:
s_mov_b64 exec, 0xffff
v_xor_b32 v7, v4, v17
v_bitop3_b32 v7, v19, v4, v7 bitop3:0xbe
v_cmp_ne_u32 vcc, 0, v7
s_cbranch_vccnz L_i0r_11
v_and_b32 v7, 15, v16
v_cmp_ne_u32 vcc, s61, v7
s_nop 0
s_cmp_eq_u64 vcc, 0
s_cselect_b32 s60, 1, 0
v_and_b32 v16, -16, v16
v_and_b32 v18, -16, v18
s_mov_b64 exec, -1
v_add_f32_dpp v16, v16, v16 quad_perm:[1,0,3,2] row_mask:0xf bank_mask:0xf
v_add_f32_dpp v18, v18, v18 quad_perm:[1,0,3,2] row_mask:0xf bank_mask:0xf
s_nop 0
v_add_f32_dpp v16, v16, v16 quad_perm:[2,3,0,1] row_mask:0xf bank_mask:0xf
v_add_f32_dpp v18, v18, v18 quad_perm:[2,3,0,1] row_mask:0xf bank_mask:0xf
s_nop 0
v_add_f32_dpp v16, v16, v16 row_half_mirror row_mask:0xf bank_mask:0xf
v_add_f32_dpp v18, v18, v18 row_half_mirror row_mask:0xf bank_mask:0xf
s_nop 0
v_add_f32_dpp v16, v16, v16 row_ror:8 row_mask:0xf bank_mask:0xf
v_add_f32_dpp v18, v18, v18 row_ror:8 row_mask:0xf bank_mask:0xf
v_mul_f32 v18, 0x3b000000, v18
v_mov_b32 v17, 0x3727c5ac
v_fmac_f32 v17, 0x3b000000, v16
v_fma_f32 v17, -v18, v18, v17
v_max_f32 v17, 0x3727c5ac, v17
v_rsq_f32 v17, v17
s_cmp_eq_u32 s73, 1
s_cbranch_scc1 L_wm_15
s_waitcnt vmcnt(0)
L_wm_15:
s_waitcnt vmcnt(16)
v_readfirstlane_b32 s70, v18
v_readfirstlane_b32 s71, v17
v_xor_b32 v8, s76, v8
v_xor_b32 v9, s48, v9
v_xor_b32 v10, s49, v10
v_xor_b32 v11, s50, v11
v_xor_b32 v12, s76, v12
v_xor_b32 v13, s48, v13
v_xor_b32 v14, s49, v14
v_xor_b32 v15, s50, v15
v_xor_b32 v20, s76, v20
v_xor_b32 v21, s48, v21
v_xor_b32 v22, s49, v22
v_xor_b32 v23, s50, v23
v_xor_b32 v24, s76, v24
v_xor_b32 v25, s48, v25
v_xor_b32 v26, s49, v26
v_xor_b32 v27, s50, v27
v_or3_b32 v6, v8, v9, v10
v_or3_b32 v6, v11, v12, v6
v_or3_b32 v6, v13, v14, v6
v_or3_b32 v6, v15, v20, v6
v_or3_b32 v6, v21, v22, v6
v_or3_b32 v6, v23, v24, v6
v_or3_b32 v6, v25, v26, v6
v_bitop3_b32 v6, v27, v6, s57 bitop3:0xa8
v_cmp_ne_u32 vcc, 0, v6
s_cbranch_vccnz L_i0r_11
s_cmp_eq_u32 s60, 0
s_cbranch_scc1 L_rs_17
L_rt_18:
s_movk_i32 s67, 0
buffer_store_dword v4, v205, s[4:7], s67 offen sc1
v_add_f32 v8, v8, v12
v_add_f32 v9, v9, v13
v_add_f32 v10, v10, v14
v_add_f32 v11, v11, v15
v_add_f32 v20, v20, v24
v_add_f32 v21, v21, v25
v_add_f32 v22, v22, v26
v_add_f32 v23, v23, v27
v_permlane32_swap_b32 v8, v10
v_permlane32_swap_b32 v9, v11
v_permlane32_swap_b32 v20, v22
v_permlane32_swap_b32 v21, v23
v_add_f32 v8, v8, v10
v_add_f32 v9, v9, v11
v_add_f32 v20, v20, v22
v_add_f32 v21, v21, v23
v_permlane16_swap_b32 v8, v9
s_nop 0
v_permlane16_swap_b32 v20, v21
v_add_f32 v8, v8, v9
v_add_f32 v20, v20, v21
s_nop 0
v_add_f32_dpp v8, v8, v8 row_ror:8 row_mask:0xf bank_mask:0xf
v_add_f32_dpp v172, v20, v20 row_ror:8 row_mask:0xf bank_mask:0xf
v_fma_f32 v8, -s70, v172, v8
v_mul_f32 v8, s71, v8
v_cvt_pk_bf16_f32 v8, v8, v8
ds_write_b16 v182, v8
s_waitcnt lgkmcnt(0)
s_barrier
s_and_b32 s64, s54, 6
s_cmp_lg_u32 s64, 4
s_cbranch_scc0 L_bs_20
s_branch L_p1b_19
L_bs_20:
v_mul_u32_u24 v6, 1056, v2
v_lshlrev_b32 v7, 4, v3
v_add3_u32 v6, s74, v6, v7
s_waitcnt vmcnt(0)
ds_read_b128 v[112:115], v6 offset:0
ds_read_b128 v[120:123], v6 offset:256
ds_read_b128 v[128:131], v6 offset:512
ds_read_b128 v[136:139], v6 offset:768
ds_read_b128 v[116:119], v6 offset:64
ds_read_b128 v[124:127], v6 offset:320
ds_read_b128 v[132:135], v6 offset:576
ds_read_b128 v[140:143], v6 offset:832
ds_read_b128 v[160:163], v6 offset:128
ds_read_b128 v[244:247], v6 offset:384
ds_read_b128 v[32:35], v6 offset:640
ds_read_b128 v[40:43], v6 offset:896
ds_read_b128 v[164:167], v6 offset:192
ds_read_b128 v[248:251], v6 offset:448
s_waitcnt lgkmcnt(8)
ds_read_b128 v[36:39], v6 offset:704
ds_read_b128 v[44:47], v6 offset:960
ds_read_b128 v[8:11], v183 offset:0
ds_read_b128 v[12:15], v183 offset:64
s_mov_b32 s64, 98304
s_mov_b32 s65, 0x3e0293ee
v_mov_b32 v212, 0
v_mov_b32 v213, 0
v_mov_b32 v216, 0
v_mov_b32 v217, 0
v_mov_b32 v220, 0
v_mov_b32 v221, 0
v_mov_b32 v224, 0
v_mov_b32 v225, 0
s_waitcnt lgkmcnt(1)
v_smfmac_f32_16x16x64_bf16 v[212:215], v[8:11], v[112:119], v108
v_smfmac_f32_16x16x64_bf16 v[216:219], v[8:11], v[120:127], v108
v_smfmac_f32_16x16x64_bf16 v[220:223], v[8:11], v[128:135], v108
v_smfmac_f32_16x16x64_bf16 v[224:227], v[8:11], v[136:143], v108
s_waitcnt lgkmcnt(0)
v_smfmac_f32_16x16x64_bf16 v[212:215], v[12:15], v[160:167], v108
v_smfmac_f32_16x16x64_bf16 v[216:219], v[12:15], v[244:251], v108
v_smfmac_f32_16x16x64_bf16 v[220:223], v[12:15], v[32:39], v108
v_smfmac_f32_16x16x64_bf16 v[224:227], v[12:15], v[40:47], v108
s_nop 4
v_add_f32 v24, v212, v213
v_add_f32 v25, v216, v217
v_add_f32 v26, v220, v221
v_add_f32 v27, v224, v225
v_mul_f32 v24, s65, v24
v_mul_f32 v25, s65, v25
v_mul_f32 v26, s65, v26
v_mul_f32 v27, s65, v27
v_add_u32 v10, 0x10000, v24
v_add_u32 v11, 0x10000, v25
v_perm_b32 v10, v11, v10, s58
v_bfi_b32 v8, s56, v252, v10
v_add_u32 v12, 0x10000, v26
v_add_u32 v13, 0x10000, v27
v_perm_b32 v12, v13, v12, s58
v_bfi_b32 v9, s56, v253, v12
s_mov_b32 s65, 106496
buffer_store_dwordx2 v[8:9], v184, s[4:7], s64 offen sc1
buffer_store_dwordx2 v[8:9], v184, s[4:7], s65 offen sc1
L_p1b_19:
s_mov_b32 s26, 4194304
s_mov_b32 s27, 0x20000
s_mov_b32 s30, 4194304
s_mov_b32 s31, 0x20000
s_mov_b32 s46, 2048
s_mov_b32 s47, 0x20000
s_sleep 24
s_lshl_b32 s64, s69, 3
s_add_u32 s64, s64, s54
s_lshl_b32 s64, s64, 9
s_add_u32 s64, s64, s68
s_lshl_b32 s64, s64, 8
v_lshlrev_b32 v6, 13, v3
v_lshl_add_u32 v6, v2, 4, v6
v_add_u32 v6, s64, v6
s_mul_i32 s66, s54, 4224
s_mov_b32 s64, 0
s_add_u32 m0, s66, 67840
s_nop 0
buffer_load_dwordx4 v6, s[24:27], s64 offen lds
s_mov_b32 s64, 32768
s_add_u32 m0, s66, 68896
s_nop 0
buffer_load_dwordx4 v6, s[24:27], s64 offen lds
s_mov_b32 s64, 65536
s_add_u32 m0, s66, 69952
s_nop 0
buffer_load_dwordx4 v6, s[24:27], s64 offen lds
s_mov_b32 s64, 98304
s_add_u32 m0, s66, 71008
s_nop 0
buffer_load_dwordx4 v6, s[24:27], s64 offen lds
v_lshlrev_b32 v7, 4, v1
v_bfe_u32 v14, v1, 2, 2
v_and_b32 v15, 3, v1
v_mov_b32 v13, 2147483392
v_bfe_u32 v10, v2, 2, 1
v_lshlrev_b32 v11, 4, v3
v_and_b32 v9, 7, v1
v_lshlrev_b32 v9, 4, v9
v_and_b32 v6, 1, v2
v_lshl_add_u32 v6, v6, 7, v11
v_lshl_add_u32 v6, v10, 8, v6
v_add_u32 v193, 135424, v6
v_and_b32 v6, 3, v1
v_lshlrev_b32 v6, 3, v6
v_lshrrev_b32 v6, v6, v4
v_bfe_u32 v240, v6, 0, 2
v_lshl_or_b32 v240, v240, 15, v240
v_and_b32 v240, s56, v240
v_bfe_u32 v241, v6, 2, 2
v_lshl_or_b32 v241, v241, 15, v241
v_and_b32 v241, s56, v241
v_bfe_u32 v242, v6, 4, 2
v_lshl_or_b32 v242, v242, 15, v242
v_and_b32 v242, s56, v242
v_bfe_u32 v243, v6, 6, 2
v_lshl_or_b32 v243, v243, 15, v243
v_and_b32 v243, s56, v243
v_lshlrev_b32 v6, 3, v15
v_lshrrev_b32 v28, v6, v4
s_and_b32 s64, s68, 15
s_lshl_b32 s64, s64, 2
s_add_u32 s64, s64, s69
s_lshl_b32 s64, s64, 4
s_and_b32 s66, s54, 4
s_add_u32 s64, s64, s66
s_add_u32 s64, s64, s54
s_lshl_b32 s64, s64, 11
v_add_u32 v185, s64, v7
v_lshlrev_b32 v6, 5, v3
v_xor_b32 v185, v6, v185
v_xor_b32 v100, 128, v185
s_lshl_b32 s75, s54, 11
v_add_u32 v186, s75, v7
v_lshlrev_b32 v6, 1, v3
v_xor_b32 v6, v6, v1
v_and_b32 v6, 3, v6
v_lshlrev_b32 v6, 3, v6
v_lshrrev_b32 v6, v6, v4
v_bfe_u32 v96, v6, 0, 2
v_lshl_or_b32 v96, v96, 15, v96
v_and_b32 v96, s56, v96
v_bfe_u32 v97, v6, 2, 2
v_lshl_or_b32 v97, v97, 15, v97
v_and_b32 v97, s56, v97
v_bfe_u32 v98, v6, 4, 2
v_lshl_or_b32 v98, v98, 15, v98
v_and_b32 v98, s56, v98
v_bfe_u32 v99, v6, 6, 2
v_lshl_or_b32 v99, v99, 15, v99
v_and_b32 v99, s56, v99
s_lshr_b32 s64, s52, 2
s_lshl_b32 s64, s64, 12
s_and_b32 s66, s68, 15
s_lshl_b32 s66, s66, 3
s_add_u32 s64, s64, s66
v_lshrrev_b32 v6, 5, v1
v_and_b32 v12, 31, v1
v_lshlrev_b32 v12, 7, v12
v_lshl_add_u32 v12, v6, 14, v12
v_add_u32 v187, s64, v12
v_lshlrev_b32 v6, 6, v6
v_lshl_add_u32 v6, v14, 4, v6
v_and_b32 v12, 1, v3
v_lshl_add_u32 v6, v12, 3, v6
v_lshl_add_u32 v6, v15, 1, v6
v_add_u32 v188, 135168, v6
v_add_u32 v6, 135168, v11
v_add_u32 v12, 135296, v11
v_cmp_eq_u32 vcc, 0, v2
s_nop 1
v_cndmask_b32 v189, v12, v6, vcc
v_add_u32 v6, 64, v6
v_cmp_eq_u32 vcc, 4, v2
s_nop 1
v_cndmask_b32 v190, v12, v6, vcc
s_barrier
s_lshl_b32 s64, s52, 19
s_lshl_b32 s65, s54, 16
s_add_u32 s64, s64, s65
s_lshl_b32 s65, s53, 6
s_add_u32 s64, s64, s65
v_lshrrev_b32 v12, 2, v1
v_lshlrev_b32 v6, 10, v12
v_lshl_add_u32 v6, v15, 4, v6
v_add_u32 v6, s64, v6
s_lshl_b32 s66, s54, 12
s_and_b32 s67, s53, 1
s_lshl_b32 s67, s67, 11
v_mov_b32 v23, v6
s_add_u32 s74, s66, 101632
s_xor_b32 s64, s67, 0
s_add_u32 m0, s64, s74
s_lshl_b32 s64, s64, 4
buffer_load_dwordx4 v23, s[28:31], s64 offen lds
s_xor_b32 s64, s67, 1024
s_add_u32 m0, s64, s74
s_lshl_b32 s64, s64, 4
buffer_load_dwordx4 v23, s[28:31], s64 offen lds
v_mov_b32 v24, 4128768
buffer_load_dword v24, v24, s[4:7], 0 offen
v_mov_b32 v25, 4194304
buffer_load_dword v25, v25, s[4:7], 0 offen
v_mov_b32 v26, 8388608
buffer_load_dword v26, v26, s[4:7], 0 offen
s_mov_b32 s10, 2048
s_mov_b32 s11, 0x20000
v_and_b32 v8, 1, v3
v_lshlrev_b32 v8, 10, v8
v_lshl_add_u32 v8, v2, 1, v8
v_add_u32 v8, s65, v8
buffer_load_ushort v18, v8, s[8:11], 0 offen
buffer_load_ushort v19, v8, s[8:11], 0 offen offset:32
s_lshl_b32 s64, s54, 5
v_and_b32 v6, 7, v12
v_xor_b32 v6, s54, v6
v_lshlrev_b32 v6, 5, v6
v_lshl_add_u32 v6, v12, 8, v6
v_lshl_add_u32 v191, v15, 3, v6
v_bfe_u32 v6, v12, 1, 2
v_lshlrev_b32 v6, 5, v6
v_lshl_add_u32 v6, v12, 7, v6
v_lshl_add_u32 v6, v15, 3, v6
v_add_u32 v203, 18432, v6
v_xor_b32 v101, 32, v203
v_xor_b32 v102, 64, v203
v_xor_b32 v103, 96, v203
s_lshl_b32 s64, s54, 4
s_add_u32 s64, s64, 135424
v_bfe_u32 v6, v2, 1, 1
v_lshlrev_b32 v6, 7, v6
v_lshl_add_u32 v6, v3, 8, v6
v_and_b32 v8, 12, v2
v_add_u32 v6, v6, v8
v_and_b32 v8, 1, v2
v_lshl_add_u32 v6, v8, 1, v6
v_add_u32 v6, s64, v6
v_mov_b32 v12, 141120
v_cmp_gt_u32 vcc, 32, v1
s_nop 1
v_cndmask_b32 v192, v12, v6, vcc
s_lshl_b32 s65, s54, 8
s_add_u32 s65, s65, 138240
v_lshlrev_b32 v6, 3, v1
v_add_u32 v6, s65, v6
v_cndmask_b32 v198, v12, v6, vcc
v_lshlrev_b32 v6, 3, v1
v_lshrrev_b32 v8, 5, v1
v_mul_u32_u24 v8, 768, v8
v_add3_u32 v199, v6, v8, 0
v_add_u32 v199, 138240, v199
v_lshlrev_b32 v8, 2, v1
v_and_b32 v16, 1, v2
v_lshlrev_b32 v16, 2, v16
v_bfe_u32 v17, v2, 1, 2
v_and_or_b32 v17, v2, 8, v17
v_add_u32 v16, v16, v17
s_lshl_b32 s65, s62, 2
s_add_u32 s65, s65, s54
s_lshl_b32 s65, s65, 7
v_lshl_add_u32 v6, v3, 4, v16
v_lshl_add_u32 v6, v6, 2, s65
v_cndmask_b32 v194, v13, v6, vcc
v_lshlrev_b32 v16, 1, v16
v_lshrrev_b32 v16, v16, v4
v_bfe_u32 v109, v16, 0, 2
v_lshl_or_b32 v109, v109, 15, v109
v_and_b32 v109, s56, v109
s_mov_b32 s65, 3407872
buffer_load_dword v27, v194, s[4:7], s65 offen
s_mov_b32 s65, 3538944
buffer_load_dword v27, v194, s[4:7], s65 offen
s_lshl_b32 s65, s62, 8
s_add_u32 s65, s65, 2621440
buffer_load_dword v27, v8, s[4:7], s65 offen
s_and_b32 s65, s62, 64
s_add_u32 s65, s65, s62
s_lshl_b32 s65, s65, 7
v_add_u32 v6, s65, v8
v_cndmask_b32 v200, v13, v6, vcc
s_lshl_b32 s65, s52, 13
s_lshl_b32 s66, s54, 8
s_add_u32 s65, s65, s66
v_lshrrev_b32 v6, 2, v2
v_lshlrev_b32 v6, 11, v6
v_lshrrev_b32 v16, 1, v3
v_lshl_add_u32 v6, v16, 7, v6
v_bfe_u32 v16, v2, 1, 1
v_lshl_add_u32 v6, v16, 6, v6
v_and_b32 v16, 1, v3
v_and_b32 v17, 1, v2
v_lshl_add_u32 v16, v16, 1, v17
v_lshl_add_u32 v6, v16, 4, v6
v_add_u32 v195, s65, v6
v_lshlrev_b32 v16, 3, v16
v_lshrrev_b32 v16, v16, v4
v_bfe_u32 v104, v16, 0, 2
v_lshl_or_b32 v104, v104, 15, v104
v_and_b32 v104, s56, v104
v_bfe_u32 v105, v16, 2, 2
v_lshl_or_b32 v105, v105, 15, v105
v_and_b32 v105, s56, v105
v_bfe_u32 v106, v16, 4, 2
v_lshl_or_b32 v106, v106, 15, v106
v_and_b32 v106, s56, v106
v_bfe_u32 v107, v16, 6, 2
v_lshl_or_b32 v107, v107, 15, v107
v_and_b32 v107, s56, v107
s_lshl_b32 s65, s54, 8
s_add_u32 s65, s65, 138240
v_lshrrev_b32 v6, 1, v3
v_lshl_add_u32 v6, v6, 4, v2
v_and_b32 v16, 1, v3
v_lshl_add_u32 v6, v6, 1, v16
v_lshl_add_u32 v198, v6, 2, s65
s_lshl_b32 s64, s54, 8
s_add_u32 s64, s64, 135936
v_lshlrev_b32 v6, 7, v10
v_add_u32 v6, s64, v6
v_and_b32 v8, 1, v2
v_lshl_add_u32 v8, v8, 6, v11
v_add_u32 v197, v6, v8
v_lshrrev_b32 v8, 1, v3
v_lshl_add_u32 v6, v8, 5, v6
v_lshrrev_b32 v8, 3, v2
v_lshl_add_u32 v6, v8, 4, v6
v_lshl_add_u32 v6, v15, 2, v6
v_and_b32 v8, 1, v3
v_lshl_add_u32 v196, v8, 6, v6
v_lshrrev_b32 v8, 3, v0
v_lshlrev_b32 v6, 4, v0
v_add_u32 v202, 18432, v6
v_lshlrev_b32 v6, 5, v3
v_xor_b32 v9, v9, v6
s_lshl_b32 s64, s53, 7
v_and_b32 v6, 60, v8
v_add_u32 v6, v6, v8
v_lshl_add_u32 v6, v6, 11, v9
v_add_u32 v201, s64, v6
v_cmp_gt_u32 s[70:71], 43, v8
v_lshrrev_b32 v8, 3, v8
v_cmp_eq_u32 vcc, 6, v8
s_nop 0
s_or_b64 s[70:71], s[70:71], vcc
v_lshlrev_b32 v6, 7, v10
v_lshl_add_u32 v6, v3, 4, v6
v_add_u32 v6, 140288, v6
v_and_b32 v8, 11, v2
v_cmp_eq_u32 vcc, 0, v8
s_nop 1
v_cndmask_b32 v204, v12, v6, vcc
s_cmp_lg_u32 s54, 0
s_cbranch_scc1 L_k_21
v_cndmask_b32 v207, v13, v174, vcc
L_k_21:
v_mov_b32 v6, 0x3f803f80
v_mov_b32 v8, 0
v_mov_b32 v9, 0
v_mov_b32 v10, 0
v_mov_b32 v11, 0
v_lshlrev_b32 v6, 2, v2
v_add_u32 v6, 135296, v6
ds_write_b32 v6, v8
s_mov_b64 exec, s[70:71]
s_not_b64 exec, exec
ds_write_b128 v202, v[8:11]
s_mov_b64 exec, -1
s_barrier
s_xor_b32 s64, s67, 2048
s_add_u32 m0, s64, s74
s_lshl_b32 s64, s64, 4
buffer_load_dwordx4 v23, s[28:31], s64 offen lds
s_xor_b32 s64, s67, 3072
s_add_u32 m0, s64, s74
s_lshl_b32 s64, s64, 4
buffer_load_dwordx4 v23, s[28:31], s64 offen lds
v_mov_b32 v20, 128
buffer_load_dwordx2 v[20:21], v20, s[4:7], 0 offen sc1
L_px_23:
s_waitcnt vmcnt(0)
v_readfirstlane_b32 s64, v20
v_readfirstlane_b32 s101, v21
s_cmp_lg_u32 s64, s55
s_cbranch_scc1 L_pw_22
s_lshr_b32 s64, s101, 3
s_lshr_b32 s65, s61, 2
s_xor_b32 s64, s64, s65
s_and_b32 s64, s64, 1
s_lshl_b32 s100, s64, 13
v_add_u32 v187, s100, v187
v_add_u32 v201, s100, v201
v_add_u32 v206, s100, v206
s_add_u32 s64, s101, s52
s_lshl_b32 s64, s64, 1
s_xor_b32 s64, s64, s101
s_and_b32 s64, s64, 8
s_lshl_b32 s64, s64, 10
v_add_u32 v185, s64, v185
v_add_u32 v100, s64, v100
s_waitcnt lgkmcnt(0)
s_barrier
s_cmp_ge_u32 s54, 4
s_cbranch_scc1 L_k_24
v_lshlrev_b32 v18, 16, v18
v_lshlrev_b32 v19, 16, v19
v_mul_f32 v244, 0x3e000000, v18
v_mul_f32 v245, 0x3e000000, v19
v_mov_b32 v6, 0x3f803f80
v_mov_b32 v8, 0
v_cmp_eq_u32 vcc, 0, v2
s_nop 1
v_cndmask_b32 v164, v8, v6, vcc
v_cmp_eq_u32 vcc, 4, v2
s_nop 1
v_cndmask_b32 v168, v8, v6, vcc
v_mov_b32 v165, v164
v_mov_b32 v169, v168
v_mov_b32 v166, v164
v_mov_b32 v170, v168
v_mov_b32 v167, v164
v_mov_b32 v171, v168
v_lshrrev_b32 v6, 1, v3
v_lshl_add_u32 v6, v14, 2, v6
v_mul_u32_u24 v6, 1056, v6
v_and_b32 v7, 1, v3
v_lshl_add_u32 v6, v7, 9, v6
s_and_b32 s64, s54, 3
s_lshl_b32 s64, s64, 6
s_add_u32 s64, s64, 67840
v_lshl_add_u32 v6, v15, 3, v6
v_add_u32 v6, s64, v6
ds_read_b64_tr_b16 v[112:113], v6 offset:0
ds_read_b64_tr_b16 v[114:115], v6 offset:256
ds_read_b64_tr_b16 v[116:117], v6 offset:2112
ds_read_b64_tr_b16 v[118:119], v6 offset:2368
ds_read_b64_tr_b16 v[120:121], v6 offset:16896
ds_read_b64_tr_b16 v[122:123], v6 offset:17152
ds_read_b64_tr_b16 v[124:125], v6 offset:19008
ds_read_b64_tr_b16 v[126:127], v6 offset:19264
ds_read_b64_tr_b16 v[128:129], v6 offset:32
ds_read_b64_tr_b16 v[130:131], v6 offset:288
ds_read_b64_tr_b16 v[132:133], v6 offset:2144
ds_read_b64_tr_b16 v[134:135], v6 offset:2400
ds_read_b64_tr_b16 v[136:137], v6 offset:16928
ds_read_b64_tr_b16 v[138:139], v6 offset:17184
s_waitcnt lgkmcnt(8)
ds_read_b64_tr_b16 v[140:141], v6 offset:19040
ds_read_b64_tr_b16 v[142:143], v6 offset:19296
L_k_24:
v_and_b32 v8, 1, v14
v_lshlrev_b32 v8, 4, v8
v_lshl_add_u32 v8, v3, 2, v8
v_lshrrev_b32 v9, 1, v14
v_add_u32 v8, v8, v9
v_lshlrev_b32 v8, 6, v8
v_lshl_add_u32 v8, v15, 3, v8
s_lshl_b32 s64, s54, 12
s_add_u32 s64, s64, 101632
v_add_u32 v8, s64, v8
ds_read_b64_tr_b16 v[144:145], v8 offset:0
ds_read_b64_tr_b16 v[146:147], v8 offset:128
ds_read_b64_tr_b16 v[148:149], v8 offset:2048
ds_read_b64_tr_b16 v[150:151], v8 offset:2176
s_waitcnt lgkmcnt(8)
ds_read_b64_tr_b16 v[152:153], v8 offset:32
ds_read_b64_tr_b16 v[154:155], v8 offset:160
ds_read_b64_tr_b16 v[156:157], v8 offset:2080
ds_read_b64_tr_b16 v[158:159], v8 offset:2208
s_waitcnt lgkmcnt(0)
v_lshlrev_b32 v6, 1, v2
v_lshrrev_b32 v6, v6, v4
v_bfe_u32 v254, v6, 0, 2
v_lshl_or_b32 v254, v254, 15, v254
v_and_b32 v254, s56, v254
s_branch L_ov_25
L_rs_26:
s_sub_u32 s59, s59, 1
s_cbranch_scc1 L_end
s_sleep 1
s_branch L_in_27
L_rs_28:
s_sub_u32 s59, s59, 1
s_cbranch_scc1 L_end
s_sleep 1
s_branch L_in_29
L_ov_25:
s_mov_b32 s64, 4194304
s_mov_b32 s65, 32768
s_cmp_lg_u32 s54, 0
s_cbranch_scc1 L_cb_31
s_movk_i32 s63, 2048
s_mov_b64 exec, 0xff
s_waitcnt vmcnt(0)
buffer_load_dword v24, v206, s[4:7], s63 offen sc1
s_nop 15
L_can_30:
s_sub_u32 s59, s59, 1
s_cbranch_scc1 L_end
buffer_load_dword v25, v206, s[4:7], s63 offen sc1
s_waitcnt vmcnt(1)
v_cmp_ne_u32 vcc, v24, v4
s_cbranch_vccz L_co_32
buffer_load_dword v24, v206, s[4:7], s63 offen sc1
s_waitcnt vmcnt(1)
v_cmp_ne_u32 vcc, v25, v4
s_cbranch_vccnz L_can_30
L_co_32:
s_mov_b64 exec, -1
s_sleep 4
L_cb_31:
s_barrier
s_cmp_eq_u32 s54, 0
s_cbranch_scc1 L_s2w_33
L_in_27:
s_mov_b32 m0, s75
s_nop 0
buffer_load_dwordx4 v185, s[4:7], s64 offen sc1 lds
buffer_load_dwordx4 v100, s[4:7], s64 offen offset:1024 sc1 lds
s_waitcnt vmcnt(0)
ds_read_b128 v[8:11], v186
ds_read_b128 v[12:15], v186 offset:1024
s_waitcnt lgkmcnt(0)
v_xor_b32 v6, v96, v8
v_bitop3_b32 v6, v9, v97, v6 bitop3:0xbe
v_bitop3_b32 v6, v10, v98, v6 bitop3:0xbe
v_bitop3_b32 v6, v11, v99, v6 bitop3:0xbe
v_bitop3_b32 v6, v12, v96, v6 bitop3:0xbe
v_bitop3_b32 v6, v13, v97, v6 bitop3:0xbe
v_bitop3_b32 v6, v14, v98, v6 bitop3:0xbe
v_bitop3_b32 v6, v15, v99, v6 bitop3:0xbe
v_and_b32 v6, s56, v6
v_cmp_ne_u32 vcc, 0, v6
s_cbranch_vccnz L_rs_26
s_branch L_s2x_34
L_s2w_33:
L_in_29:
v_not_b32 v17, v4
buffer_load_dwordx2 v[16:17], v187, s[4:7], s65 offen sc1
s_mov_b32 m0, s75
s_nop 0
buffer_load_dwordx4 v185, s[4:7], s64 offen sc1 lds
buffer_load_dwordx4 v100, s[4:7], s64 offen offset:1024 sc1 lds
s_waitcnt vmcnt(2)
v_xor_b32 v7, v4, v17
v_mov_b32 v18, v16
s_nop 1
v_max_f32_dpp v18, v18, v18 quad_perm:[1,0,3,2] row_mask:0xf bank_mask:0xf
s_nop 1
v_max_f32_dpp v18, v18, v18 quad_perm:[2,3,0,1] row_mask:0xf bank_mask:0xf
s_nop 1
v_max_f32_dpp v18, v18, v18 row_half_mirror row_mask:0xf bank_mask:0xf
s_nop 1
v_max_f32_dpp v18, v18, v18 row_ror:8 row_mask:0xf bank_mask:0xf
v_mov_b32 v19, v18
s_nop 1
v_permlane16_swap_b32 v18, v19
v_max_f32 v18, v18, v19
v_sub_f32 v16, v16, v18
v_exp_f32 v16, v16
s_nop 0
v_mov_b32 v18, v16
s_nop 1
v_add_f32_dpp v18, v18, v18 quad_perm:[1,0,3,2] row_mask:0xf bank_mask:0xf
s_nop 1
v_add_f32_dpp v18, v18, v18 quad_perm:[2,3,0,1] row_mask:0xf bank_mask:0xf
s_nop 1
v_add_f32_dpp v18, v18, v18 row_half_mirror row_mask:0xf bank_mask:0xf
s_nop 1
v_add_f32_dpp v18, v18, v18 row_ror:8 row_mask:0xf bank_mask:0xf
v_mov_b32 v19, v18
s_nop 1
v_permlane16_swap_b32 v18, v19
v_add_f32 v18, v18, v19
v_rcp_f32 v18, v18
s_nop 0
v_mul_f32 v16, v16, v18
v_cvt_pk_bf16_f32 v16, v16, v16
ds_write_b16 v188, v16
s_waitcnt vmcnt(0)
ds_read_b128 v[8:11], v186
ds_read_b128 v[12:15], v186 offset:1024
s_waitcnt lgkmcnt(0)
v_xor_b32 v6, v96, v8
v_bitop3_b32 v6, v9, v97, v6 bitop3:0xbe
v_bitop3_b32 v6, v10, v98, v6 bitop3:0xbe
v_bitop3_b32 v6, v11, v99, v6 bitop3:0xbe
v_bitop3_b32 v6, v12, v96, v6 bitop3:0xbe
v_bitop3_b32 v6, v13, v97, v6 bitop3:0xbe
v_bitop3_b32 v6, v14, v98, v6 bitop3:0xbe
v_bitop3_b32 v6, v15, v99, v6 bitop3:0xbe
v_and_or_b32 v6, v6, s56, v7
v_cmp_ne_u32 vcc, 0, v6
s_cbranch_vccnz L_rs_28
L_s2x_34:
s_waitcnt lgkmcnt(0)
s_barrier
ds_read_b128 v[8:11], v189
ds_read_b64_tr_b16 v[16:17], v191 offset:0
ds_read_b64_tr_b16 v[18:19], v191 offset:4096
ds_read_b128 v[12:15], v190
ds_read_b64_tr_b16 v[20:21], v191 offset:8192
ds_read_b64_tr_b16 v[22:23], v191 offset:12288
s_waitcnt lgkmcnt(3)
v_and_b32 v16, s77, v16
v_and_b32 v17, s77, v17
v_and_b32 v18, s77, v18
v_and_b32 v19, s77, v19
s_waitcnt lgkmcnt(0)
v_and_b32 v20, s77, v20
v_and_b32 v21, s77, v21
v_and_b32 v22, s77, v22
v_and_b32 v23, s77, v23
v_mfma_f32_16x16x32_bf16 v[24:27], v[8:11], v[16:19], 0
s_nop 0
v_mfma_f32_16x16x32_bf16 v[24:27], v[12:15], v[20:23], v[24:27]
s_mov_b32 s65, 3407872
s_nop 6
v_cvt_pk_bf16_f32 v8, v24, v24
ds_write_b16 v192, v8
s_waitcnt lgkmcnt(0)
s_barrier
s_cmp_ge_u32 s54, 4
s_cbranch_scc0 L_bs_36
s_branch L_k_35
L_bs_36:
ds_read_b128 v[8:11], v193
ds_read_b128 v[12:15], v193 offset:64
v_mov_b32 v16, 0
v_mov_b32 v17, 0
v_mov_b32 v20, 0
v_mov_b32 v21, 0
s_waitcnt lgkmcnt(1)
v_smfmac_f32_16x16x64_bf16 v[16:19], v[8:11], v[112:119], v108
v_smfmac_f32_16x16x64_bf16 v[20:23], v[8:11], v[128:135], v108
s_waitcnt lgkmcnt(0)
v_smfmac_f32_16x16x64_bf16 v[16:19], v[12:15], v[120:127], v108
v_smfmac_f32_16x16x64_bf16 v[20:23], v[12:15], v[136:143], v108
s_cmp_eq_u32 s60, 0
s_cbranch_scc1 L_sc_37
s_nop 4
v_add_f32 v16, v16, v17
v_add_f32 v20, v20, v21
v_cvt_pk_bf16_f32 v8, v16, v20
v_bfi_b32 v8, s56, v109, v8
buffer_store_dword v8, v194, s[4:7], s65 offen
L_sd_38:
L_k_35:
v_mov_b32 v16, 0
v_mov_b32 v17, 0
v_mov_b32 v18, 0
v_mov_b32 v19, 0
v_mov_b32 v20, 0
v_mov_b32 v21, 0
v_mov_b32 v22, 0
v_mov_b32 v23, 0
L_i1_39:
s_sub_u32 s59, s59, 1
s_cbranch_scc1 L_end
buffer_load_dwordx4 v[8:11], v195, s[4:7], s65 offen sc1
s_waitcnt vmcnt(0)
v_xor_b32 v8, v104, v8
v_xor_b32 v9, v105, v9
v_xor_b32 v10, v106, v10
v_xor_b32 v11, v107, v11
v_or3_b32 v6, v8, v9, v10
v_bitop3_b32 v6, v11, v6, s56 bitop3:0xa8
v_cmp_ne_u32 vcc, 0, v6
s_cbranch_vccnz L_i1_39
v_smfmac_f32_16x16x64_bf16 v[16:19], v[8:11], v[144:151], v108
v_smfmac_f32_16x16x64_bf16 v[20:23], v[8:11], v[152:159], v108
s_movk_i32 s67, 4096
buffer_store_dword v4, v205, s[4:7], s67 offen sc1
s_nop 4
v_add_f32 v16, v16, v17
v_add_f32 v18, v18, v19
v_add_f32 v20, v20, v21
v_add_f32 v22, v22, v23
v_permlane32_swap_b32 v16, v18
s_nop 0
v_permlane32_swap_b32 v20, v22
v_add_f32 v16, v16, v18
v_add_f32 v20, v20, v22
s_nop 1
v_permlane16_swap_b32 v16, v20
v_add_f32 v16, v16, v20
ds_write_b32 v198, v16
s_waitcnt lgkmcnt(0)
s_barrier
s_cmp_lg_u32 s54, 0
s_cbranch_scc0 L_bs_41
s_branch L_fin_40
L_bs_41:
ds_read_b64 v[8:9], v199 offset:0
ds_read_b64 v[10:11], v199 offset:256
ds_read_b64 v[12:13], v199 offset:512
ds_read_b64 v[14:15], v199 offset:768
s_mov_b32 s64, 360448
s_waitcnt lgkmcnt(2)
v_pk_add_f32 v[8:9], v[8:9], v[10:11]
s_waitcnt lgkmcnt(0)
v_pk_add_f32 v[12:13], v[12:13], v[14:15]
v_pk_add_f32 v[8:9], v[8:9], v[12:13]
v_pk_add_f32 v[10:11], v[8:9], v[244:245]
s_nop 0
v_permlane32_swap_b32 v8, v12
v_permlane32_swap_b32 v9, v13
v_pk_add_f32 v[24:25], v[10:11], v[12:13]
v_add_u32 v10, 0x10000, v24
v_add_u32 v11, 0x10000, v25
v_perm_b32 v10, v11, v10, s58
v_bfi_b32 v8, s56, v254, v10
s_mov_b32 s65, 368640
buffer_store_dword v8, v200, s[4:7], s64 offen sc1
buffer_store_dword v8, v200, s[4:7], s65 offen sc1
L_fin_40:
s_lshl_b32 s64, s54, 9
s_add_u32 s64, s64, s68
s_lshl_b32 s64, s64, 8
v_lshlrev_b32 v9, 4, v2
v_lshl_add_u32 v9, v3, 15, v9
v_add_u32 v9, s64, v9
s_mul_i32 s67, s54, 4160
s_barrier
s_mov_b32 s64, 0
s_add_u32 m0, s67, 67840
s_nop 0
buffer_load_dwordx4 v9, s[16:19], s64 offen lds
s_mov_b32 s64, 8192
s_add_u32 m0, s67, 68880
s_nop 0
buffer_load_dwordx4 v9, s[16:19], s64 offen lds
s_mov_b32 s64, 16384
s_add_u32 m0, s67, 69920
s_nop 0
buffer_load_dwordx4 v9, s[16:19], s64 offen lds
s_mov_b32 s64, 24576
s_add_u32 m0, s67, 70960
s_nop 0
buffer_load_dwordx4 v9, s[16:19], s64 offen lds
s_mov_b32 s64, 1048576
s_add_u32 m0, s67, 101120
s_nop 0
buffer_load_dwordx4 v9, s[16:19], s64 offen lds
s_mov_b32 s64, 1056768
s_add_u32 m0, s67, 102160
s_nop 0
buffer_load_dwordx4 v9, s[16:19], s64 offen lds
s_mov_b32 s64, 1064960
s_add_u32 m0, s67, 103200
s_nop 0
buffer_load_dwordx4 v9, s[16:19], s64 offen lds
s_mov_b32 s64, 1073152
s_add_u32 m0, s67, 104240
s_nop 0
buffer_load_dwordx4 v9, s[16:19], s64 offen lds
v_bfe_u32 v14, v1, 2, 2
v_and_b32 v15, 3, v1
v_mov_b32 v13, 2147483392
v_lshlrev_b32 v11, 4, v3
v_bfe_u32 v12, v2, 2, 1
v_and_b32 v6, 1, v14
v_lshlrev_b32 v6, 2, v6
v_lshrrev_b32 v8, 1, v14
v_add_u32 v6, v6, v8
v_and_b32 v8, 1, v3
v_lshl_add_u32 v6, v8, 1, v6
v_mul_u32_u24 v6, 1040, v6
v_lshrrev_b32 v8, 1, v3
v_lshl_add_u32 v6, v8, 8, v6
v_lshl_add_u32 v6, v15, 3, v6
s_lshl_b32 s64, s54, 5
s_add_u32 s64, s64, 67840
v_add_u32 v10, s64, v6
s_and_b32 s64, s54, 1
s_lshl_b32 s65, s64, 5
v_xor_b32 v110, s65, v203
v_xor_b32 v111, 64, v110
s_lshl_b32 s65, s64, 6
v_add_u32 v204, s65, v204
s_lshl_b32 s65, s62, 8
s_lshl_b32 s64, s64, 4
s_add_u32 s65, s65, s64
s_add_u32 s65, s65, 2621440
v_lshlrev_b32 v6, 7, v12
v_lshl_add_u32 v6, v3, 5, v6
v_add_u32 v6, s65, v6
v_and_b32 v8, 11, v2
v_cmp_eq_u32 vcc, 0, v8
s_nop 1
v_cndmask_b32 v175, v13, v6, vcc
v_add_u32 v6, s64, v174
v_cndmask_b32 v207, v13, v6, vcc
s_lshl_b32 s64, s52, 12
v_lshlrev_b32 v6, 4, v0
v_add_u32 v178, s64, v6
v_bfe_u32 v6, v0, 3, 1
v_mul_u32_u24 v6, 1152, v6
v_lshrrev_b32 v8, 4, v0
v_lshl_add_u32 v6, v8, 5, v6
v_bfe_u32 v8, v0, 2, 1
v_lshl_add_u32 v6, v8, 4, v6
v_lshl_add_u32 v6, v15, 2, v6
v_add_u32 v179, 135936, v6
v_and_b32 v8, 1, v2
v_lshl_add_u32 v6, v12, 1, v8
v_mul_u32_u24 v6, 576, v6
v_add_u32 v6, v6, v11
v_add_u32 v6, 135936, v6
v_mov_b32 v16, 140608
v_lshrrev_b32 v17, 1, v2
v_cmp_eq_u32 vcc, 1, v17
s_nop 1
v_cndmask_b32 v180, v6, v16, vcc
v_lshl_add_u32 v6, v8, 7, v11
v_lshlrev_b32 v16, 8, v12
v_mov_b32 v17, 0x200
v_and_b32 v8, 2, v2
v_cmp_ne_u32 vcc, 0, v8
s_nop 1
v_cndmask_b32 v16, v16, v17, vcc
v_add3_u32 v183, v6, v16, 0
v_add_u32 v183, 134400, v183
v_add_u32 v182, 4294966272, v192
s_lshl_b32 s64, s54, 3
s_add_u32 s64, s64, 140544
v_lshlrev_b32 v6, 2, v1
v_add_u32 v6, s64, v6
v_mov_b32 v8, 141120
s_cmp_lt_u32 s54, 4
s_cselect_b32 vcc_lo, 0x101, 0
s_mov_b32 vcc_hi, 0
v_cndmask_b32 v181, v8, v6, vcc
v_and_b32 v6, 1, v3
v_lshlrev_b32 v6, 5, v6
v_add_u32 v177, 140544, v6
s_and_b32 s64, s54, 1
s_mul_i32 s64, s64, 16896
s_add_u32 s64, s64, 34048
v_mul_u32_u24 v6, 1056, v2
v_add3_u32 v176, s64, v6, v11
v_and_b32 v6, 127, v0
v_lshlrev_b32 v6, 2, v6
v_add_u32 v6, 140608, v6
v_mov_b32 v8, 0x3f803f80
ds_write_b32 v6, v8
s_waitcnt vmcnt(4)
s_barrier
ds_read_b64_tr_b16 v[32:33], v10 offset:0
ds_read_b64_tr_b16 v[34:35], v10 offset:512
ds_read_b64_tr_b16 v[36:37], v10 offset:8320
ds_read_b64_tr_b16 v[38:39], v10 offset:8832
ds_read_b64_tr_b16 v[40:41], v10 offset:16640
ds_read_b64_tr_b16 v[42:43], v10 offset:17152
ds_read_b64_tr_b16 v[44:45], v10 offset:24960
ds_read_b64_tr_b16 v[46:47], v10 offset:25472
s_waitcnt lgkmcnt(0)
s_barrier
s_mov_b32 s64, 2097152
s_add_u32 m0, s67, 67840
s_nop 0
buffer_load_dwordx4 v9, s[16:19], s64 offen lds
s_mov_b32 s64, 2105344
s_add_u32 m0, s67, 68880
s_nop 0
buffer_load_dwordx4 v9, s[16:19], s64 offen lds
s_mov_b32 s64, 2113536
s_add_u32 m0, s67, 69920
s_nop 0
buffer_load_dwordx4 v9, s[16:19], s64 offen lds
s_mov_b32 s64, 2121728
s_add_u32 m0, s67, 70960
s_nop 0
buffer_load_dwordx4 v9, s[16:19], s64 offen lds
s_waitcnt vmcnt(4)
s_barrier
ds_read_b64_tr_b16 v[48:49], v10 offset:33280
ds_read_b64_tr_b16 v[50:51], v10 offset:33792
ds_read_b64_tr_b16 v[52:53], v10 offset:41600
ds_read_b64_tr_b16 v[54:55], v10 offset:42112
ds_read_b64_tr_b16 v[56:57], v10 offset:49920
ds_read_b64_tr_b16 v[58:59], v10 offset:50432
ds_read_b64_tr_b16 v[60:61], v10 offset:58240
ds_read_b64_tr_b16 v[62:63], v10 offset:58752
s_waitcnt lgkmcnt(0)
s_barrier
s_mov_b32 s64, 3145728
s_add_u32 m0, s67, 101120
s_nop 0
buffer_load_dwordx4 v9, s[16:19], s64 offen lds
s_mov_b32 s64, 3153920
s_add_u32 m0, s67, 102160
s_nop 0
buffer_load_dwordx4 v9, s[16:19], s64 offen lds
s_mov_b32 s64, 3162112
s_add_u32 m0, s67, 103200
s_nop 0
buffer_load_dwordx4 v9, s[16:19], s64 offen lds
s_mov_b32 s64, 3170304
s_add_u32 m0, s67, 104240
s_nop 0
buffer_load_dwordx4 v9, s[16:19], s64 offen lds
s_waitcnt vmcnt(4)
s_barrier
ds_read_b64_tr_b16 v[64:65], v10 offset:0
ds_read_b64_tr_b16 v[66:67], v10 offset:512
ds_read_b64_tr_b16 v[68:69], v10 offset:8320
ds_read_b64_tr_b16 v[70:71], v10 offset:8832
ds_read_b64_tr_b16 v[72:73], v10 offset:16640
ds_read_b64_tr_b16 v[74:75], v10 offset:17152
ds_read_b64_tr_b16 v[76:77], v10 offset:24960
ds_read_b64_tr_b16 v[78:79], v10 offset:25472
s_waitcnt lgkmcnt(0)
s_waitcnt vmcnt(0)
s_barrier
ds_read_b64_tr_b16 v[80:81], v10 offset:33280
ds_read_b64_tr_b16 v[82:83], v10 offset:33792
ds_read_b64_tr_b16 v[84:85], v10 offset:41600
ds_read_b64_tr_b16 v[86:87], v10 offset:42112
ds_read_b64_tr_b16 v[88:89], v10 offset:49920
ds_read_b64_tr_b16 v[90:91], v10 offset:50432
ds_read_b64_tr_b16 v[92:93], v10 offset:58240
ds_read_b64_tr_b16 v[94:95], v10 offset:58752
s_waitcnt lgkmcnt(0)
s_mov_b32 s65, 425984
s_cmp_eq_u32 s54, 6
s_cselect_b32 s65, 163840, s65
s_lshl_b32 s66, s54, 10
s_add_u32 s66, s66, 18432
s_branch L_ov_42
L_rs_43:
s_sub_u32 s59, s59, 1
s_cbranch_scc1 L_end
s_sleep 1
s_branch L_in_44
L_ov_42:
s_cmp_lg_u32 s54, 0
s_cbranch_scc1 L_cb_46
s_movk_i32 s63, 6144
s_mov_b64 exec, 0xff
s_waitcnt vmcnt(0)
buffer_load_dword v24, v206, s[4:7], s63 offen sc1
s_nop 15
L_can_45:
s_sub_u32 s59, s59, 1
s_cbranch_scc1 L_end
buffer_load_dword v25, v206, s[4:7], s63 offen sc1
s_waitcnt vmcnt(1)
v_cmp_ne_u32 vcc, v24, v4
s_cbranch_vccz L_co_47
buffer_load_dword v24, v206, s[4:7], s63 offen sc1
s_waitcnt vmcnt(1)
v_cmp_ne_u32 vcc, v25, v4
s_cbranch_vccnz L_can_45
L_co_47:
s_mov_b64 exec, -1
s_sleep 3
L_cb_46:
s_barrier
s_mov_b64 exec, s[70:71]
s_cbranch_execz L_s45n_48
L_in_44:
buffer_load_dwordx4 v[8:11], v201, s[4:7], s65 offen sc1
s_waitcnt vmcnt(0)
v_xor_b32 v8, v96, v8
v_xor_b32 v9, v97, v9
v_xor_b32 v10, v98, v10
v_xor_b32 v11, v99, v11
ds_write_b128 v202, v[8:11]
v_or3_b32 v6, v8, v9, v10
v_bitop3_b32 v6, v11, v6, s56 bitop3:0xa8
v_cmp_ne_u32 vcc, 0, v6
s_cbranch_vccnz L_rs_43
L_s45n_48:
s_mov_b64 exec, -1
s_waitcnt lgkmcnt(0)
s_barrier
s_cmp_ge_u32 s54, 2
s_cbranch_scc0 L_bs_50
s_branch L_k_49
L_bs_50:
ds_read_b64_tr_b16 v[8:9], v110 offset:0
ds_read_b64_tr_b16 v[10:11], v110 offset:2048
ds_read_b64_tr_b16 v[12:13], v111 offset:0
ds_read_b64_tr_b16 v[14:15], v111 offset:2048
ds_read_b64_tr_b16 v[16:17], v110 offset:4096
ds_read_b64_tr_b16 v[18:19], v110 offset:6144
ds_read_b64_tr_b16 v[20:21], v111 offset:4096
ds_read_b64_tr_b16 v[22:23], v111 offset:6144
s_waitcnt lgkmcnt(6)
v_mfma_f32_16x16x32_bf16 v[244:247], v[8:11], v[164:167], 0
s_waitcnt lgkmcnt(4)
v_mfma_f32_16x16x32_bf16 v[244:247], v[12:15], v[168:171], v[244:247]
s_waitcnt lgkmcnt(2)
v_mfma_f32_16x16x32_bf16 v[244:247], v[16:19], v[164:167], v[244:247]
s_waitcnt lgkmcnt(0)
v_mfma_f32_16x16x32_bf16 v[244:247], v[20:23], v[168:171], v[244:247]
s_cmp_eq_u32 s60, 0
s_cbranch_scc1 L_sc_51
s_nop 5
v_bfi_b32 v8, s57, v4, v244
v_bfi_b32 v9, s57, v208, v245
v_bfi_b32 v10, s57, v209, v246
v_bfi_b32 v11, s57, v210, v247
buffer_store_dwordx4 v[8:11], v175, s[4:7], 0 offen
L_sd_52:
v_mul_f32 v244, 0x3e000000, v244
ds_write_b32 v204, v244 offset:0
v_mul_f32 v245, 0x3e000000, v245
ds_write_b32 v204, v245 offset:4
v_mul_f32 v246, 0x3e000000, v246
ds_write_b32 v204, v246 offset:8
v_mul_f32 v247, 0x3e000000, v247
ds_write_b32 v204, v247 offset:12
L_k_49:
v_mov_b32 v212, 0
v_mov_b32 v213, 0
v_mov_b32 v214, 0
v_mov_b32 v215, 0
v_mov_b32 v216, 0
v_mov_b32 v217, 0
v_mov_b32 v218, 0
v_mov_b32 v219, 0
v_mov_b32 v220, 0
v_mov_b32 v221, 0
v_mov_b32 v222, 0
v_mov_b32 v223, 0
v_mov_b32 v224, 0
v_mov_b32 v225, 0
v_mov_b32 v226, 0
v_mov_b32 v227, 0
v_mov_b32 v16, 0
v_mov_b32 v17, 0
v_mov_b32 v18, 0
v_mov_b32 v19, 0
s_mov_b32 s64, 2621440
s_cmp_ge_u32 s54, 4
s_cbranch_scc1 L_k_53
s_sleep 1
L_xg_54:
s_sub_u32 s59, s59, 1
s_cbranch_scc1 L_end
buffer_load_dwordx4 v[8:11], v178, s[4:7], s64 offen sc1
s_waitcnt vmcnt(0)
v_xor_b32 v8, s76, v8
v_xor_b32 v9, s48, v9
v_xor_b32 v10, s49, v10
v_xor_b32 v11, s50, v11
v_cvt_pk_bf16_f32 v12, v8, v9
v_cvt_pk_bf16_f32 v13, v10, v11
ds_write_b32 v179, v12
ds_write_b32 v179, v13 offset:576
v_or3_b32 v6, v8, v9, v10
v_bitop3_b32 v6, v11, v6, s57 bitop3:0xa8
v_cmp_ne_u32 vcc, 0, v6
s_cbranch_vccnz L_xg_54
L_k_53:
s_waitcnt lgkmcnt(0)
s_barrier
ds_read_b128 v[20:23], v180 offset:0
ds_read_b128 v[24:27], v180 offset:64
ds_read_b128 v[228:231], v180 offset:128
ds_read_b128 v[232:235], v180 offset:192
s_cmp_ge_u32 s54, 4
s_cbranch_scc1 L_k_55
v_add_f32 v7, v8, v9
v_mul_f32 v6, v8, v8
v_add_f32 v12, v10, v11
v_fmac_f32 v6, v9, v9
v_add_f32 v7, v7, v12
v_fmac_f32 v6, v10, v10
v_fmac_f32 v6, v11, v11
s_waitcnt lgkmcnt(3)
v_smfmac_f32_16x16x64_bf16 v[16:19], v[20:23], v[32:39], v108
ds_read_b128 v[20:23], v180 offset:256
v_add_f32_dpp v6, v6, v6 quad_perm:[1,0,3,2] row_mask:0xf bank_mask:0xf
v_add_f32_dpp v7, v7, v7 quad_perm:[1,0,3,2] row_mask:0xf bank_mask:0xf
s_waitcnt lgkmcnt(3)
v_smfmac_f32_16x16x64_bf16 v[16:19], v[24:27], v[40:47], v108
ds_read_b128 v[24:27], v180 offset:320
v_add_f32_dpp v6, v6, v6 quad_perm:[2,3,0,1] row_mask:0xf bank_mask:0xf
v_add_f32_dpp v7, v7, v7 quad_perm:[2,3,0,1] row_mask:0xf bank_mask:0xf
s_waitcnt lgkmcnt(3)
v_smfmac_f32_16x16x64_bf16 v[16:19], v[228:231], v[48:55], v108
ds_read_b128 v[228:231], v180 offset:384
v_add_f32_dpp v6, v6, v6 row_half_mirror row_mask:0xf bank_mask:0xf
v_add_f32_dpp v7, v7, v7 row_half_mirror row_mask:0xf bank_mask:0xf
s_waitcnt lgkmcnt(3)
v_smfmac_f32_16x16x64_bf16 v[16:19], v[232:235], v[56:63], v108
ds_read_b128 v[232:235], v180 offset:448
v_mov_b32 v12, v6
v_mov_b32 v13, v7
s_waitcnt lgkmcnt(3)
v_smfmac_f32_16x16x64_bf16 v[16:19], v[20:23], v[64:71], v108
v_permlane16_swap_b32 v6, v12
v_permlane16_swap_b32 v7, v13
s_waitcnt lgkmcnt(2)
v_smfmac_f32_16x16x64_bf16 v[16:19], v[24:27], v[72:79], v108
v_add_f32 v6, v6, v12
v_add_f32 v7, v7, v13
v_mov_b32 v12, v6
v_mov_b32 v13, v7
s_waitcnt lgkmcnt(1)
v_smfmac_f32_16x16x64_bf16 v[16:19], v[228:231], v[80:87], v108
v_permlane32_swap_b32 v6, v12
v_permlane32_swap_b32 v7, v13
s_waitcnt lgkmcnt(0)
v_smfmac_f32_16x16x64_bf16 v[16:19], v[232:235], v[88:95], v108
v_add_f32 v6, v6, v12
v_add_f32 v7, v7, v13
ds_write_b64 v181, v[6:7]
s_branch L_k_56
L_k_55:
s_waitcnt lgkmcnt(3)
v_smfmac_f32_16x16x64_bf16 v[16:19], v[20:23], v[32:39], v108
ds_read_b128 v[20:23], v180 offset:256
s_waitcnt lgkmcnt(3)
v_smfmac_f32_16x16x64_bf16 v[16:19], v[24:27], v[40:47], v108
ds_read_b128 v[24:27], v180 offset:320
s_waitcnt lgkmcnt(3)
v_smfmac_f32_16x16x64_bf16 v[16:19], v[228:231], v[48:55], v108
ds_read_b128 v[228:231], v180 offset:384
s_waitcnt lgkmcnt(3)
v_smfmac_f32_16x16x64_bf16 v[16:19], v[232:235], v[56:63], v108
ds_read_b128 v[232:235], v180 offset:448
s_waitcnt lgkmcnt(3)
v_smfmac_f32_16x16x64_bf16 v[16:19], v[20:23], v[64:71], v108
s_waitcnt lgkmcnt(2)
v_smfmac_f32_16x16x64_bf16 v[16:19], v[24:27], v[72:79], v108
s_waitcnt lgkmcnt(1)
v_smfmac_f32_16x16x64_bf16 v[16:19], v[228:231], v[80:87], v108
s_waitcnt lgkmcnt(0)
v_smfmac_f32_16x16x64_bf16 v[16:19], v[232:235], v[88:95], v108
s_cmp_ge_u32 s54, 6
s_cbranch_scc1 L_k_56
ds_read_b128 v[32:35], v176 offset:640
ds_read_b128 v[36:39], v176 offset:704
ds_read_b128 v[40:43], v176 offset:896
ds_read_b128 v[44:47], v176 offset:960
L_k_56:
s_nop 5
v_add_f32 v16, v16, v17
v_add_f32 v18, v18, v19
v_cvt_pk_bf16_f32 v16, v16, v18
s_mov_b32 exec_hi, 0
ds_write_b16 v182, v16
s_mov_b64 exec, 0xffff
ds_write_b16_d16_hi v182, v16 offset:512
s_mov_b64 exec, -1
s_waitcnt lgkmcnt(0)
s_barrier
s_and_b32 s64, s54, 6
s_cmp_lg_u32 s64, 4
s_cbranch_scc0 L_bs_58
s_movk_i32 s67, 1024
buffer_store_dword v4, v205, s[4:7], s67 offen sc1
s_branch L_p1b_57
L_bs_58:
ds_read_b128 v[8:11], v183
ds_read_b128 v[12:15], v183 offset:64
ds_read_b128 v[16:19], v177
ds_read_b128 v[20:23], v177 offset:16
s_mov_b32 s64, 229376
s_mov_b32 s65, 0x3e0293ee
s_waitcnt lgkmcnt(3)
v_smfmac_f32_16x16x64_bf16 v[212:215], v[8:11], v[112:119], v108
v_smfmac_f32_16x16x64_bf16 v[216:219], v[8:11], v[120:127], v108
v_smfmac_f32_16x16x64_bf16 v[220:223], v[8:11], v[128:135], v108
v_smfmac_f32_16x16x64_bf16 v[224:227], v[8:11], v[136:143], v108
s_waitcnt lgkmcnt(2)
v_smfmac_f32_16x16x64_bf16 v[212:215], v[12:15], v[160:167], v108
v_smfmac_f32_16x16x64_bf16 v[216:219], v[12:15], v[244:251], v108
v_smfmac_f32_16x16x64_bf16 v[220:223], v[12:15], v[32:39], v108
v_smfmac_f32_16x16x64_bf16 v[224:227], v[12:15], v[40:47], v108
s_waitcnt lgkmcnt(0)
v_add_f32 v16, v16, v18
v_add_f32 v17, v17, v19
v_add_f32 v20, v20, v22
v_add_f32 v21, v21, v23
v_add_f32 v16, v16, v20
v_add_f32 v17, v17, v21
v_mul_f32 v17, 0x3b000000, v17
v_mov_b32 v18, 0x3727c5ac
v_fmac_f32 v18, 0x3b000000, v16
v_fma_f32 v18, -v17, v17, v18
v_max_f32 v18, 0x3727c5ac, v18
v_rsq_f32 v18, v18
s_nop 0
v_mul_f32 v18, s65, v18
v_add_f32 v24, v212, v213
v_add_f32 v20, v214, v215
v_add_f32 v25, v216, v217
v_add_f32 v21, v218, v219
v_add_f32 v26, v220, v221
v_add_f32 v22, v222, v223
v_add_f32 v27, v224, v225
v_add_f32 v23, v226, v227
v_fma_f32 v24, -v17, v20, v24
v_fma_f32 v25, -v17, v21, v25
v_fma_f32 v26, -v17, v22, v26
v_fma_f32 v27, -v17, v23, v27
v_mul_f32 v24, v18, v24
v_mul_f32 v25, v18, v25
v_mul_f32 v26, v18, v26
v_mul_f32 v27, v18, v27
v_add_u32 v10, 0x10000, v24
v_add_u32 v11, 0x10000, v25
v_perm_b32 v10, v11, v10, s58
v_bfi_b32 v8, s56, v252, v10
v_add_u32 v12, 0x10000, v26
v_add_u32 v13, 0x10000, v27
v_perm_b32 v12, v13, v12, s58
v_bfi_b32 v9, s56, v253, v12
s_mov_b32 s65, 237568
buffer_store_dwordx2 v[8:9], v184, s[4:7], s64 offen sc1
buffer_store_dwordx2 v[8:9], v184, s[4:7], s65 offen sc1
L_p1b_57:
s_cmp_lg_u32 s54, 0
s_cbranch_scc1 L_k_59
v_and_b32 v6, 31, v1
v_lshlrev_b32 v6, 3, v6
v_add_u32 v6, 140288, v6
ds_read_b64 v[244:245], v6
L_k_59:
s_lshl_b32 s64, s2, 9
v_add_u32 v6, s64, v0
v_mov_b32 v7, 2147483392
v_cmp_eq_u32 vcc, 0, v6
s_nop 1
v_cndmask_b32 v6, v7, v6, vcc
buffer_store_dword v4, v6, s[4:7], 0 offen sc1
s_branch L_ov_60
L_rs_61:
s_sub_u32 s59, s59, 1
s_cbranch_scc1 L_end
s_sleep 1
s_branch L_in_62
L_rs_63:
s_sub_u32 s59, s59, 1
s_cbranch_scc1 L_end
s_sleep 1
s_branch L_in_64
L_ov_60:
s_mov_b32 s64, 8388608
s_mov_b32 s65, 65536
s_cmp_lg_u32 s54, 0
s_cbranch_scc1 L_cb_66
s_movk_i32 s63, 3072
s_mov_b64 exec, 0xff
s_waitcnt vmcnt(0)
buffer_load_dword v24, v206, s[4:7], s63 offen sc1
s_nop 15
L_can_65:
s_sub_u32 s59, s59, 1
s_cbranch_scc1 L_end
buffer_load_dword v25, v206, s[4:7], s63 offen sc1
s_waitcnt vmcnt(1)
v_cmp_ne_u32 vcc, v24, v4
s_cbranch_vccz L_co_67
buffer_load_dword v24, v206, s[4:7], s63 offen sc1
s_waitcnt vmcnt(1)
v_cmp_ne_u32 vcc, v25, v4
s_cbranch_vccnz L_can_65
L_co_67:
s_mov_b64 exec, -1
s_sleep 11
L_cb_66:
s_barrier
s_cmp_eq_u32 s54, 0
s_cbranch_scc1 L_s2w_68
L_in_62:
s_mov_b32 m0, s75
s_nop 0
buffer_load_dwordx4 v185, s[4:7], s64 offen sc1 lds
buffer_load_dwordx4 v100, s[4:7], s64 offen offset:1024 sc1 lds
s_waitcnt vmcnt(0)
ds_read_b128 v[8:11], v186
ds_read_b128 v[12:15], v186 offset:1024
s_waitcnt lgkmcnt(0)
v_xor_b32 v6, v96, v8
v_bitop3_b32 v6, v9, v97, v6 bitop3:0xbe
v_bitop3_b32 v6, v10, v98, v6 bitop3:0xbe
v_bitop3_b32 v6, v11, v99, v6 bitop3:0xbe
v_bitop3_b32 v6, v12, v96, v6 bitop3:0xbe
v_bitop3_b32 v6, v13, v97, v6 bitop3:0xbe
v_bitop3_b32 v6, v14, v98, v6 bitop3:0xbe
v_bitop3_b32 v6, v15, v99, v6 bitop3:0xbe
v_and_b32 v6, s56, v6
v_cmp_ne_u32 vcc, 0, v6
s_cbranch_vccnz L_rs_61
s_branch L_s2x_69
L_s2w_68:
L_in_64:
v_not_b32 v17, v4
buffer_load_dwordx2 v[16:17], v187, s[4:7], s65 offen sc1
s_mov_b32 m0, s75
s_nop 0
buffer_load_dwordx4 v185, s[4:7], s64 offen sc1 lds
buffer_load_dwordx4 v100, s[4:7], s64 offen offset:1024 sc1 lds
s_waitcnt vmcnt(2)
v_xor_b32 v7, v4, v17
v_mov_b32 v18, v16
s_nop 1
v_max_f32_dpp v18, v18, v18 quad_perm:[1,0,3,2] row_mask:0xf bank_mask:0xf
s_nop 1
v_max_f32_dpp v18, v18, v18 quad_perm:[2,3,0,1] row_mask:0xf bank_mask:0xf
s_nop 1
v_max_f32_dpp v18, v18, v18 row_half_mirror row_mask:0xf bank_mask:0xf
s_nop 1
v_max_f32_dpp v18, v18, v18 row_ror:8 row_mask:0xf bank_mask:0xf
v_mov_b32 v19, v18
s_nop 1
v_permlane16_swap_b32 v18, v19
v_max_f32 v18, v18, v19
v_sub_f32 v16, v16, v18
v_exp_f32 v16, v16
s_nop 0
v_mov_b32 v18, v16
s_nop 1
v_add_f32_dpp v18, v18, v18 quad_perm:[1,0,3,2] row_mask:0xf bank_mask:0xf
s_nop 1
v_add_f32_dpp v18, v18, v18 quad_perm:[2,3,0,1] row_mask:0xf bank_mask:0xf
s_nop 1
v_add_f32_dpp v18, v18, v18 row_half_mirror row_mask:0xf bank_mask:0xf
s_nop 1
v_add_f32_dpp v18, v18, v18 row_ror:8 row_mask:0xf bank_mask:0xf
v_mov_b32 v19, v18
s_nop 1
v_permlane16_swap_b32 v18, v19
v_add_f32 v18, v18, v19
v_rcp_f32 v18, v18
s_nop 0
v_mul_f32 v16, v16, v18
v_cvt_pk_bf16_f32 v16, v16, v16
ds_write_b16 v188, v16
s_waitcnt vmcnt(0)
ds_read_b128 v[8:11], v186
ds_read_b128 v[12:15], v186 offset:1024
s_waitcnt lgkmcnt(0)
v_xor_b32 v6, v96, v8
v_bitop3_b32 v6, v9, v97, v6 bitop3:0xbe
v_bitop3_b32 v6, v10, v98, v6 bitop3:0xbe
v_bitop3_b32 v6, v11, v99, v6 bitop3:0xbe
v_bitop3_b32 v6, v12, v96, v6 bitop3:0xbe
v_bitop3_b32 v6, v13, v97, v6 bitop3:0xbe
v_bitop3_b32 v6, v14, v98, v6 bitop3:0xbe
v_bitop3_b32 v6, v15, v99, v6 bitop3:0xbe
v_and_or_b32 v6, v6, s56, v7
v_cmp_ne_u32 vcc, 0, v6
s_cbranch_vccnz L_rs_63
L_s2x_69:
s_waitcnt lgkmcnt(0)
s_barrier
ds_read_b128 v[8:11], v189
ds_read_b64_tr_b16 v[16:17], v191 offset:0
ds_read_b64_tr_b16 v[18:19], v191 offset:4096
ds_read_b128 v[12:15], v190
ds_read_b64_tr_b16 v[20:21], v191 offset:8192
ds_read_b64_tr_b16 v[22:23], v191 offset:12288
s_waitcnt lgkmcnt(3)
v_and_b32 v16, s77, v16
v_and_b32 v17, s77, v17
v_and_b32 v18, s77, v18
v_and_b32 v19, s77, v19
s_waitcnt lgkmcnt(0)
v_and_b32 v20, s77, v20
v_and_b32 v21, s77, v21
v_and_b32 v22, s77, v22
v_and_b32 v23, s77, v23
v_mfma_f32_16x16x32_bf16 v[24:27], v[8:11], v[16:19], 0
s_nop 0
v_mfma_f32_16x16x32_bf16 v[24:27], v[12:15], v[20:23], v[24:27]
s_mov_b32 s65, 3538944
s_nop 6
v_cvt_pk_bf16_f32 v8, v24, v24
ds_write_b16 v192, v8
s_waitcnt lgkmcnt(0)
s_barrier
s_cmp_ge_u32 s54, 4
s_cbranch_scc0 L_bs_71
s_branch L_k_70
L_bs_71:
ds_read_b128 v[8:11], v193
ds_read_b128 v[12:15], v193 offset:64
v_mov_b32 v16, 0
v_mov_b32 v17, 0
v_mov_b32 v20, 0
v_mov_b32 v21, 0
s_waitcnt lgkmcnt(1)
v_smfmac_f32_16x16x64_bf16 v[16:19], v[8:11], v[112:119], v108
v_smfmac_f32_16x16x64_bf16 v[20:23], v[8:11], v[128:135], v108
s_waitcnt lgkmcnt(0)
v_smfmac_f32_16x16x64_bf16 v[16:19], v[12:15], v[120:127], v108
v_smfmac_f32_16x16x64_bf16 v[20:23], v[12:15], v[136:143], v108
s_cmp_eq_u32 s60, 0
s_cbranch_scc1 L_sc_72
s_nop 4
v_add_f32 v16, v16, v17
v_add_f32 v20, v20, v21
v_cvt_pk_bf16_f32 v8, v16, v20
v_bfi_b32 v8, s56, v109, v8
buffer_store_dword v8, v194, s[4:7], s65 offen
L_sd_73:
L_k_70:
v_mov_b32 v16, 0
v_mov_b32 v17, 0
v_mov_b32 v18, 0
v_mov_b32 v19, 0
v_mov_b32 v20, 0
v_mov_b32 v21, 0
v_mov_b32 v22, 0
v_mov_b32 v23, 0
L_i1_74:
s_sub_u32 s59, s59, 1
s_cbranch_scc1 L_end
buffer_load_dwordx4 v[8:11], v195, s[4:7], s65 offen sc1
s_waitcnt vmcnt(0)
v_xor_b32 v8, v104, v8
v_xor_b32 v9, v105, v9
v_xor_b32 v10, v106, v10
v_xor_b32 v11, v107, v11
v_or3_b32 v6, v8, v9, v10
v_bitop3_b32 v6, v11, v6, s56 bitop3:0xa8
v_cmp_ne_u32 vcc, 0, v6
s_cbranch_vccnz L_i1_74
v_smfmac_f32_16x16x64_bf16 v[16:19], v[8:11], v[144:151], v108
v_smfmac_f32_16x16x64_bf16 v[20:23], v[8:11], v[152:159], v108
s_movk_i32 s67, 5120
buffer_store_dword v4, v205, s[4:7], s67 offen sc1
s_nop 4
v_add_f32 v16, v16, v17
v_add_f32 v18, v18, v19
v_add_f32 v20, v20, v21
v_add_f32 v22, v22, v23
v_permlane32_swap_b32 v16, v18
s_nop 0
v_permlane32_swap_b32 v20, v22
v_add_f32 v16, v16, v18
v_add_f32 v20, v20, v22
s_nop 1
v_permlane16_swap_b32 v16, v20
v_add_f32 v16, v16, v20
ds_write_b32 v198, v16
s_waitcnt lgkmcnt(0)
s_barrier
s_cmp_lg_u32 s54, 0
s_cbranch_scc0 L_bs_76
s_branch L_fin_75
L_bs_76:
ds_read_b64 v[8:9], v199 offset:0
ds_read_b64 v[10:11], v199 offset:256
ds_read_b64 v[12:13], v199 offset:512
ds_read_b64 v[14:15], v199 offset:768
s_mov_b32 s64, 393216
s_waitcnt lgkmcnt(2)
v_pk_add_f32 v[8:9], v[8:9], v[10:11]
s_waitcnt lgkmcnt(0)
v_pk_add_f32 v[12:13], v[12:13], v[14:15]
v_pk_add_f32 v[8:9], v[8:9], v[12:13]
v_pk_add_f32 v[10:11], v[8:9], v[244:245]
s_nop 0
v_permlane32_swap_b32 v8, v12
v_permlane32_swap_b32 v9, v13
v_pk_add_f32 v[24:25], v[10:11], v[12:13]
v_add_u32 v10, 0x10000, v24
v_add_u32 v11, 0x10000, v25
v_perm_b32 v10, v11, v10, s58
v_bfi_b32 v8, s56, v254, v10
s_mov_b32 s65, 401408
buffer_store_dword v8, v200, s[4:7], s64 offen sc1
buffer_store_dword v8, v200, s[4:7], s65 offen sc1
L_fin_75:
s_and_b32 s64, s53, 7
s_cmp_eq_u32 s64, s52
s_cbranch_scc1 L_ex_77
s_endpgm
L_ex_77:
s_mov_b32 s65, 606208
s_cmp_eq_u32 s54, 6
s_cselect_b32 s65, 196608, s65
s_lshl_b32 s66, s54, 10
s_add_u32 s66, s66, 18432
s_branch L_ov_78
L_rs_79:
s_sub_u32 s59, s59, 1
s_cbranch_scc1 L_end
s_sleep 1
s_branch L_in_80
L_ov_78:
s_cmp_lg_u32 s54, 0
s_cbranch_scc1 L_cb_82
s_movk_i32 s63, 7168
s_mov_b64 exec, 0xff
s_waitcnt vmcnt(0)
buffer_load_dword v24, v206, s[4:7], s63 offen sc1
s_nop 15
L_can_81:
s_sub_u32 s59, s59, 1
s_cbranch_scc1 L_end
buffer_load_dword v25, v206, s[4:7], s63 offen sc1
s_waitcnt vmcnt(1)
v_cmp_ne_u32 vcc, v24, v4
s_cbranch_vccz L_co_83
buffer_load_dword v24, v206, s[4:7], s63 offen sc1
s_waitcnt vmcnt(1)
v_cmp_ne_u32 vcc, v25, v4
s_cbranch_vccnz L_can_81
L_co_83:
s_mov_b64 exec, -1
s_sleep 3
L_cb_82:
s_barrier
s_mov_b64 exec, s[70:71]
s_cbranch_execz L_s45n_84
L_in_80:
buffer_load_dwordx4 v[8:11], v201, s[4:7], s65 offen sc1
s_waitcnt vmcnt(0)
v_xor_b32 v8, v96, v8
v_xor_b32 v9, v97, v9
v_xor_b32 v10, v98, v10
v_xor_b32 v11, v99, v11
ds_write_b128 v202, v[8:11]
v_or3_b32 v6, v8, v9, v10
v_bitop3_b32 v6, v11, v6, s56 bitop3:0xa8
v_cmp_ne_u32 vcc, 0, v6
s_cbranch_vccnz L_rs_79
L_s45n_84:
s_mov_b64 exec, -1
s_waitcnt lgkmcnt(0)
s_barrier
s_cmp_ge_u32 s54, 2
s_cbranch_scc0 L_bs_86
s_endpgm
L_bs_86:
ds_read_b64_tr_b16 v[8:9], v110 offset:0
ds_read_b64_tr_b16 v[10:11], v110 offset:2048
ds_read_b64_tr_b16 v[12:13], v111 offset:0
ds_read_b64_tr_b16 v[14:15], v111 offset:2048
ds_read_b64_tr_b16 v[16:17], v110 offset:4096
ds_read_b64_tr_b16 v[18:19], v110 offset:6144
ds_read_b64_tr_b16 v[20:21], v111 offset:4096
ds_read_b64_tr_b16 v[22:23], v111 offset:6144
s_waitcnt lgkmcnt(6)
v_mfma_f32_16x16x32_bf16 v[244:247], v[8:11], v[164:167], 0
s_waitcnt lgkmcnt(4)
v_mfma_f32_16x16x32_bf16 v[244:247], v[12:15], v[168:171], v[244:247]
s_waitcnt lgkmcnt(2)
v_mfma_f32_16x16x32_bf16 v[244:247], v[16:19], v[164:167], v[244:247]
s_waitcnt lgkmcnt(0)
v_mfma_f32_16x16x32_bf16 v[244:247], v[20:23], v[168:171], v[244:247]
s_nop 7
v_cvt_pk_bf16_f32 v8, v244, v246
v_cvt_pk_bf16_f32 v9, v245, v247
buffer_store_dword v8, v207, s[44:47], 0 offen
buffer_store_dword v9, v207, s[44:47], 0 offen offset:32
s_endpgm
.p2align 12
L_roleB:
s_load_dwordx2 s[20:21], s[0:1], 24
s_load_dwordx2 s[12:13], s[0:1], 8
v_lshrrev_b32 v6, 6, v0
v_and_b32 v1, 63, v0
s_and_b32 s52, s2, 7
v_readfirstlane_b32 s54, v6
s_sub_u32 s53, s53, 16
v_lshrrev_b32 v6, 3, v0
v_lshlrev_b32 v6, 13, v6
v_and_b32 v8, 7, v0
v_lshl_add_u32 v8, v8, 7, v6
s_lshl_b32 s63, s53, 8
s_add_u32 s63, s63, s52
s_lshl_b32 s63, s63, 10
s_mov_b32 s22, 4194304
s_mov_b32 s23, 0x20000
s_mov_b32 s14, 8388608
s_mov_b32 s15, 0x20000
s_lshr_b32 s68, s52, 2
s_and_b32 s69, s53, 1
s_and_b32 s64, s52, 3
s_lshl_b32 s64, s64, 3
s_lshr_b32 s76, s53, 1
s_add_u32 s76, s76, s64
v_lshlrev_b32 v7, 4, v1
s_lshl_b32 s64, s68, 22
s_lshl_b32 s65, s76, 17
s_add_u32 s64, s64, s65
s_and_b32 s74, s54, 7
s_lshl_b32 s65, s74, 14
s_add_u32 s64, s64, s65
v_add_u32 v31, s64, v7
s_mul_i32 s74, s74, 16896
s_lshl_b32 s75, s69, 12
s_sub_u32 s77, s2, 128
s_getreg_b32 s61, hwreg(HW_REG_XCC_ID)
s_and_b32 s61, s61, 15
s_lshl_b32 s64, s77, 2
s_lshr_b32 s65, s54, 1
s_add_u32 s64, s64, s65
s_lshr_b32 s65, s64, 6
s_lshl_b32 s65, s65, 1
s_and_b32 s66, s54, 1
s_add_u32 s65, s65, s66
s_lshl_b32 s65, s65, 6
s_and_b32 s64, s64, 63
s_add_u32 s64, s64, s65
s_lshl_b32 s64, s64, 7
s_add_u32 s64, s64, 1048576
s_waitcnt lgkmcnt(0)
s_cmp_eq_u32 s54, 7
s_cbranch_scc1 L_nv_87
s_memtime s[72:73]
s_load_dword s65, s[4:5], s64
s_waitcnt lgkmcnt(0)
s_memtime s[70:71]
s_waitcnt lgkmcnt(0)
s_sub_u32 s66, s70, s72
v_mov_b32 v6, s66
s_lshl_b32 s64, s54, 2
s_add_u32 s64, s64, 160640
v_mov_b32 v9, s64
ds_write_b32 v9, v6
s_waitcnt lgkmcnt(0)
s_barrier
s_sleep 4
s_cmp_ge_u32 s54, 4
s_cbranch_scc1 L_nh_89
buffer_load_dword v255, v8, s[20:23], s63 offen
L_nh_89:
s_load_dword s55, s[4:5], 0
s_mov_b32 s6, 268435456
s_mov_b32 s7, 0x20000
s_branch L_nw_88
L_nv_87:
s_load_dword s55, s[4:5], 0
s_getpc_b64 s[72:73]
L_pc:
s_sub_u32 s72, s72, L_pc-interleave_layers__compressed_kv_cla__glu_gated_geglu__decode_kernel
s_subb_u32 s73, s73, 0
s_lshl_b32 s64, s53, 11
v_lshlrev_b32 v6, 5, v1
v_add_u32 v6, s64, v6
v_min_u32 v6, L_code_end-interleave_layers__compressed_kv_cla__glu_gated_geglu__decode_kernel-4, v6
global_load_dword v255, v6, s[72:73]
s_mov_b32 s6, 268435456
s_mov_b32 s7, 0x20000
v_mov_b32 v6, 160640
s_lshr_b32 s64, s61, 2
s_and_b32 s65, s77, 0x70
s_add_u32 s65, s65, s77
s_lshl_b32 s65, s65, 2
s_waitcnt lgkmcnt(0)
s_add_u32 s55, s55, 1
s_cselect_b32 s55, 2, s55
v_mov_b32 v4, s55
s_barrier
ds_read_b128 v[8:11], v6
ds_read_b128 v[12:15], v6 offset:16
v_mov_b32 v6, 1024
s_waitcnt lgkmcnt(0)
v_min3_u32 v8, v8, v10, v12
v_min3_u32 v9, v9, v11, v13
v_min_u32 v8, v8, v14
v_cmp_lt_u32 vcc, v9, v8
s_nop 1
v_cndmask_b32 v8, 0, 1, vcc
v_xor_b32 v8, s64, v8
v_lshlrev_b32 v8, 31, v8
v_xor_b32 v8, v4, v8
s_mov_b64 exec, 1
buffer_store_dword v8, v6, s[4:7], s65 offen sc1
s_mov_b64 exec, -1
s_sub_u32 s55, s55, 1
L_nw_88:
s_load_dwordx2 s[28:29], s[0:1], 40
s_load_dwordx2 s[32:33], s[0:1], 56
s_load_dwordx2 s[36:37], s[0:1], 64
s_load_dwordx2 s[40:41], s[0:1], 72
s_sleep 10
s_barrier
s_xor_b32 s64, s75, 0
s_add_u32 m0, s74, 0
s_nop 0
buffer_load_dwordx4 v31, s[12:15], s64 offen lds
s_xor_b32 s64, s75, 1024
s_add_u32 m0, s74, 1056
s_nop 0
buffer_load_dwordx4 v31, s[12:15], s64 offen lds
s_xor_b32 s64, s75, 2048
s_add_u32 m0, s74, 2112
s_nop 0
buffer_load_dwordx4 v31, s[12:15], s64 offen lds
s_xor_b32 s64, s75, 3072
s_add_u32 m0, s74, 3168
s_nop 0
buffer_load_dwordx4 v31, s[12:15], s64 offen lds
s_xor_b32 s64, s75, 8192
s_add_u32 m0, s74, 4224
s_nop 0
buffer_load_dwordx4 v31, s[12:15], s64 offen lds
s_xor_b32 s64, s75, 9216
s_add_u32 m0, s74, 5280
s_nop 0
buffer_load_dwordx4 v31, s[12:15], s64 offen lds
s_xor_b32 s64, s75, 10240
s_add_u32 m0, s74, 6336
s_nop 0
buffer_load_dwordx4 v31, s[12:15], s64 offen lds
s_xor_b32 s64, s75, 11264
s_add_u32 m0, s74, 7392
s_nop 0
buffer_load_dwordx4 v31, s[12:15], s64 offen lds
s_mov_b32 s56, 0x00010001
s_movk_i32 s57, 0xff
s_mov_b32 s58, 0x07060302
s_mov_b32 s59, 4194304
v_and_b32 v2, 15, v0
v_bfe_u32 v3, v0, 4, 2
v_mov_b32 v13, 2147483392
v_mov_b32 v12, 160640
v_bfe_u32 v14, v1, 2, 2
v_and_b32 v15, 3, v1
s_mov_b32 s30, 4194304
s_mov_b32 s31, 0x20000
s_mov_b32 s34, 1409024
s_mov_b32 s35, 0x20000
s_mov_b32 s38, 1409024
s_mov_b32 s39, 0x20000
s_mov_b32 s42, 1409024
s_mov_b32 s43, 0x20000
s_lshl_b32 s64, s68, 16
s_lshl_b32 s65, s69, 15
s_add_u32 s64, s64, s65
s_and_b32 s65, s54, 4
s_add_u32 s65, s65, s54
s_lshl_b32 s65, s65, 11
s_add_u32 s64, s64, s65
v_add_u32 v224, s64, v7
s_mul_i32 s64, s54, 2112
s_add_u32 s64, s64, 135168
v_add_u32 v225, s64, v7
v_lshlrev_b32 v11, 4, v3
v_mul_u32_u24 v6, 1056, v2
v_add_u32 v6, v6, v11
v_add_u32 v226, 135168, v6
s_mul_i32 s64, s54, 16896
v_add_u32 v30, s64, v6
v_lshlrev_b32 v6, 5, v2
v_add_u32 v227, 152064, v6
s_lshl_b32 s64, s54, 6
s_add_u32 s64, s64, 153088
v_add_u32 v228, s64, v11
v_mul_u32_u24 v6, 288, v2
v_add_u32 v6, v6, v11
v_add_u32 v230, 155904, v6
s_lshr_b32 s64, s54, 1
s_lshl_b32 s64, s64, 6
s_and_b32 s65, s54, 1
s_lshl_b32 s66, s65, 3
s_add_u32 s64, s64, s66
v_add_u32 v229, s64, v230
s_lshr_b32 s66, s54, 1
s_lshl_b32 s64, s66, 15
s_lshl_b32 s66, s68, 14
s_add_u32 s64, s64, s66
s_lshl_b32 s66, s76, 8
s_add_u32 s64, s64, s66
s_lshl_b32 s66, s65, 7
s_add_u32 s64, s64, s66
v_lshlrev_b32 v6, 19, v3
v_lshl_add_u32 v6, v2, 3, v6
v_add_u32 v231, s64, v6
s_lshl_b32 s64, s68, 2
s_add_u32 s64, s64, s69
s_lshl_b32 s64, s64, 5
s_add_u32 s64, s64, s76
s_lshl_b32 s64, s64, 7
v_lshlrev_b32 v6, 3, v2
v_lshl_add_u32 v6, v3, 13, v6
v_add_u32 v232, s64, v6
s_lshl_b32 s64, s53, 9
v_xor_b32 v6, 0, v0
v_add_u32 v6, s64, v6
s_lshl_b32 s64, s52, 7
s_add_u32 s64, s64, 16384
v_lshl_add_u32 v8, v6, 13, s64
v_cmp_gt_u32 vcc, 2, v6
s_nop 1
v_cndmask_b32 v233, v13, v8, vcc
v_and_b32 v6, 7, v0
v_lshlrev_b32 v6, 7, v6
v_add_u32 v234, 16384, v6
v_mov_b32 v235, v13
v_mov_b32 v244, v13
v_mov_b32 v8, 0x3f803f80
v_and_b32 v6, 31, v1
v_lshlrev_b32 v6, 2, v6
v_add_u32 v6, 160512, v6
ds_write_b32 v6, v8
v_lshrrev_b32 v6, 2, v1
v_mul_u32_u24 v6, 1056, v6
v_lshl_add_u32 v6, v15, 3, v6
s_lshl_b32 s64, s54, 7
v_add_u32 v28, s64, v6
v_add_u32 v29, 67584, v28
s_waitcnt lgkmcnt(0)
s_add_u32 s55, s55, 1
s_cselect_b32 s55, 2, s55
v_mov_b32 v4, s55
v_and_b32 v6, 3, v1
v_lshlrev_b32 v6, 3, v6
v_lshrrev_b32 v6, v6, v4
v_bfe_u32 v251, v6, 0, 2
v_lshl_or_b32 v251, v251, 15, v251
v_and_b32 v251, s56, v251
v_bfe_u32 v252, v6, 2, 2
v_lshl_or_b32 v252, v252, 15, v252
v_and_b32 v252, s56, v252
v_bfe_u32 v253, v6, 4, 2
v_lshl_or_b32 v253, v253, 15, v253
v_and_b32 v253, s56, v253
v_bfe_u32 v254, v6, 6, 2
v_lshl_or_b32 v254, v254, 15, v254
v_and_b32 v254, s56, v254
v_and_b32 v6, 7, v2
v_lshlrev_b32 v6, 2, v6
v_lshrrev_b32 v6, v6, v4
v_bfe_u32 v247, v6, 0, 2
v_lshl_or_b32 v247, v247, 15, v247
v_and_b32 v247, s56, v247
v_bfe_u32 v248, v6, 2, 2
v_lshl_or_b32 v248, v248, 15, v248
v_and_b32 v248, s56, v248
v_lshlrev_b32 v6, 1, v2
v_lshrrev_b32 v6, v6, v4
v_bfe_u32 v249, v6, 0, 2
v_lshl_or_b32 v249, v249, 15, v249
v_and_b32 v249, s56, v249
s_barrier
s_xor_b32 s64, s75, 4096
s_add_u32 m0, s74, 8448
s_nop 0
buffer_load_dwordx4 v31, s[12:15], s64 offen lds
s_xor_b32 s64, s75, 5120
s_add_u32 m0, s74, 9504
s_nop 0
buffer_load_dwordx4 v31, s[12:15], s64 offen lds
s_xor_b32 s64, s75, 6144
s_add_u32 m0, s74, 10560
s_nop 0
buffer_load_dwordx4 v31, s[12:15], s64 offen lds
s_xor_b32 s64, s75, 7168
s_add_u32 m0, s74, 11616
s_nop 0
buffer_load_dwordx4 v31, s[12:15], s64 offen lds
s_xor_b32 s64, s75, 12288
s_add_u32 m0, s74, 12672
s_nop 0
buffer_load_dwordx4 v31, s[12:15], s64 offen lds
s_xor_b32 s64, s75, 13312
s_add_u32 m0, s74, 13728
s_nop 0
buffer_load_dwordx4 v31, s[12:15], s64 offen lds
s_xor_b32 s64, s75, 14336
s_add_u32 m0, s74, 14784
s_nop 0
buffer_load_dwordx4 v31, s[12:15], s64 offen lds
s_xor_b32 s64, s75, 15360
s_add_u32 m0, s74, 15840
s_nop 0
buffer_load_dwordx4 v31, s[12:15], s64 offen lds
L_h2_91:
v_mov_b32 v16, 2304
buffer_load_dword v16, v16, s[4:7], 0 offen
v_mov_b32 v17, 4194304
buffer_load_dword v17, v17, s[4:7], 0 offen
v_mov_b32 v18, 8388608
buffer_load_dword v18, v18, s[4:7], 0 offen
v_mov_b32 v20, 128
buffer_load_dwordx2 v[20:21], v20, s[4:7], 0 offen sc1
s_mul_i32 s74, s54, 2112
s_add_u32 s74, s74, 135168
s_lshl_b32 s63, s52, 4
s_add_u32 s63, s63, s53
s_lshl_b32 s63, s63, 15
s_cmp_lg_u32 s54, 7
s_cbranch_scc1 L_cb_94
s_movk_i32 s63, 0
s_mov_b64 exec, 0xff
L_can_93:
s_sub_u32 s59, s59, 1
s_cbranch_scc1 L_end
buffer_load_dword v6, v234, s[4:7], s63 offen sc1
s_waitcnt vmcnt(0)
v_cmp_ne_u32 vcc, v6, v4
s_cbranch_vccnz L_can_93
s_mov_b64 exec, -1
L_cb_94:
s_cmp_lt_u32 s54, 4
s_cselect_b32 s66, 0, 0
L_pu_97:
s_waitcnt vmcnt(0)
ds_read_b128 v[32:35], v30 offset:0
ds_read_b128 v[36:39], v30 offset:64
ds_read_b128 v[40:43], v30 offset:128
ds_read_b128 v[44:47], v30 offset:192
ds_read_b128 v[48:51], v30 offset:256
ds_read_b128 v[52:55], v30 offset:320
ds_read_b128 v[56:59], v30 offset:384
ds_read_b128 v[60:63], v30 offset:448
ds_read_b128 v[64:67], v30 offset:512
ds_read_b128 v[68:71], v30 offset:576
ds_read_b128 v[72:75], v30 offset:640
ds_read_b128 v[76:79], v30 offset:704
ds_read_b128 v[80:83], v30 offset:768
ds_read_b128 v[84:87], v30 offset:832
s_waitcnt lgkmcnt(8)
ds_read_b128 v[88:91], v30 offset:896
ds_read_b128 v[92:95], v30 offset:960
v_readfirstlane_b32 s60, v20
v_readfirstlane_b32 s101, v21
s_cmp_lg_u32 s60, s55
s_cbranch_scc1 L_pt_96
s_lshr_b32 s64, s101, 3
s_lshr_b32 s65, s61, 2
s_xor_b32 s64, s64, s65
s_and_b32 s64, s64, 1
s_lshl_b32 s100, s64, 13
v_add_u32 v224, s100, v224
v_add_u32 v234, s100, v234
s_lshl_b32 s64, s69, 2
s_add_u32 s64, s64, s101
v_add_u32 v6, s64, v3
v_lshlrev_b32 v6, 1, v6
v_xor_b32 v6, s101, v6
v_and_b32 v6, 8, v6
v_lshl_add_u32 v231, v6, 10, v231
L_pq_95:
s_barrier
s_mov_b32 s64, 98304
buffer_load_dwordx4 v[8:11], v224, s[4:7], s64 offen sc1
buffer_load_dwordx4 v[12:15], v224, s[4:7], s64 offen offset:1024 sc1
ds_read_b64_tr_b16 v[96:97], v28 offset:0
ds_read_b64_tr_b16 v[98:99], v28 offset:16896
ds_read_b64_tr_b16 v[100:101], v28 offset:32
ds_read_b64_tr_b16 v[102:103], v28 offset:16928
s_waitcnt lgkmcnt(8)
ds_read_b64_tr_b16 v[104:105], v28 offset:64
ds_read_b64_tr_b16 v[106:107], v28 offset:16960
ds_read_b64_tr_b16 v[108:109], v28 offset:96
ds_read_b64_tr_b16 v[110:111], v28 offset:16992
ds_read_b64_tr_b16 v[112:113], v28 offset:33792
ds_read_b64_tr_b16 v[114:115], v28 offset:50688
s_waitcnt lgkmcnt(8)
ds_read_b64_tr_b16 v[116:117], v28 offset:33824
ds_read_b64_tr_b16 v[118:119], v28 offset:50720
ds_read_b64_tr_b16 v[120:121], v28 offset:33856
ds_read_b64_tr_b16 v[122:123], v28 offset:50752
ds_read_b64_tr_b16 v[124:125], v28 offset:33888
ds_read_b64_tr_b16 v[126:127], v28 offset:50784
s_waitcnt lgkmcnt(8)
ds_read_b64_tr_b16 v[128:129], v29 offset:0
ds_read_b64_tr_b16 v[130:131], v29 offset:16896
ds_read_b64_tr_b16 v[132:133], v29 offset:32
ds_read_b64_tr_b16 v[134:135], v29 offset:16928
ds_read_b64_tr_b16 v[136:137], v29 offset:64
ds_read_b64_tr_b16 v[138:139], v29 offset:16960
s_waitcnt lgkmcnt(8)
ds_read_b64_tr_b16 v[140:141], v29 offset:96
ds_read_b64_tr_b16 v[142:143], v29 offset:16992
ds_read_b64_tr_b16 v[144:145], v29 offset:33792
ds_read_b64_tr_b16 v[146:147], v29 offset:50688
ds_read_b64_tr_b16 v[148:149], v29 offset:33824
ds_read_b64_tr_b16 v[150:151], v29 offset:50720
s_waitcnt lgkmcnt(8)
ds_read_b64_tr_b16 v[152:153], v29 offset:33856
ds_read_b64_tr_b16 v[154:155], v29 offset:50752
ds_read_b64_tr_b16 v[156:157], v29 offset:33888
ds_read_b64_tr_b16 v[158:159], v29 offset:50784
L_in_98:
s_waitcnt vmcnt(0)
v_xor_b32 v8, v251, v8
v_xor_b32 v9, v252, v9
v_xor_b32 v10, v253, v10
v_xor_b32 v11, v254, v11
v_xor_b32 v12, v251, v12
v_xor_b32 v13, v252, v13
v_xor_b32 v14, v253, v14
v_xor_b32 v15, v254, v15
ds_write_b128 v225, v[8:11]
ds_write_b128 v225, v[12:15] offset:1056
v_or3_b32 v6, v8, v9, v10
v_or3_b32 v6, v11, v12, v6
v_or3_b32 v6, v13, v14, v6
v_bitop3_b32 v6, v15, v6, s56 bitop3:0xa8
v_cmp_ne_u32 vcc, 0, v6
s_cbranch_vccnz L_s1_92
s_waitcnt lgkmcnt(0)
s_barrier
ds_read_b128 v[8:11], v226 offset:0
ds_read_b128 v[12:15], v226 offset:64
ds_read_b128 v[16:19], v226 offset:128
ds_read_b128 v[20:23], v226 offset:192
ds_read_b128 v[28:31], v226 offset:256
s_waitcnt lgkmcnt(4)
v_mfma_f32_16x16x32_bf16 v[24:27], v[32:35], v[8:11], 0
ds_read_b128 v[8:11], v226 offset:320
s_waitcnt lgkmcnt(4)
v_mfma_f32_16x16x32_bf16 v[24:27], v[36:39], v[12:15], v[24:27]
ds_read_b128 v[12:15], v226 offset:384
s_waitcnt lgkmcnt(4)
v_mfma_f32_16x16x32_bf16 v[24:27], v[40:43], v[16:19], v[24:27]
ds_read_b128 v[16:19], v226 offset:448
s_waitcnt lgkmcnt(4)
v_mfma_f32_16x16x32_bf16 v[24:27], v[44:47], v[20:23], v[24:27]
ds_read_b128 v[20:23], v226 offset:512
s_waitcnt lgkmcnt(4)
v_mfma_f32_16x16x32_bf16 v[24:27], v[48:51], v[28:31], v[24:27]
ds_read_b128 v[28:31], v226 offset:576
s_waitcnt lgkmcnt(4)
v_mfma_f32_16x16x32_bf16 v[24:27], v[52:55], v[8:11], v[24:27]
ds_read_b128 v[8:11], v226 offset:640
s_waitcnt lgkmcnt(4)
v_mfma_f32_16x16x32_bf16 v[24:27], v[56:59], v[12:15], v[24:27]
ds_read_b128 v[12:15], v226 offset:704
s_waitcnt lgkmcnt(4)
v_mfma_f32_16x16x32_bf16 v[24:27], v[60:63], v[16:19], v[24:27]
ds_read_b128 v[16:19], v226 offset:768
s_waitcnt lgkmcnt(4)
v_mfma_f32_16x16x32_bf16 v[24:27], v[64:67], v[20:23], v[24:27]
ds_read_b128 v[20:23], v226 offset:832
s_waitcnt lgkmcnt(4)
v_mfma_f32_16x16x32_bf16 v[24:27], v[68:71], v[28:31], v[24:27]
ds_read_b128 v[28:31], v226 offset:896
s_waitcnt lgkmcnt(4)
v_mfma_f32_16x16x32_bf16 v[24:27], v[72:75], v[8:11], v[24:27]
ds_read_b128 v[8:11], v226 offset:960
s_waitcnt lgkmcnt(4)
v_mfma_f32_16x16x32_bf16 v[24:27], v[76:79], v[12:15], v[24:27]
s_waitcnt lgkmcnt(3)
v_mfma_f32_16x16x32_bf16 v[24:27], v[80:83], v[16:19], v[24:27]
s_waitcnt lgkmcnt(2)
v_mfma_f32_16x16x32_bf16 v[24:27], v[84:87], v[20:23], v[24:27]
s_waitcnt lgkmcnt(1)
v_mfma_f32_16x16x32_bf16 v[24:27], v[88:91], v[28:31], v[24:27]
s_waitcnt lgkmcnt(0)
v_mfma_f32_16x16x32_bf16 v[24:27], v[92:95], v[8:11], v[24:27]
s_lshl_b32 s64, s54, 2
v_add_u32 v7, s64, v227
s_nop 5
v_max3_f32 v8, v24, v25, v26
v_max_f32 v8, v8, v27
v_mov_b32 v9, v8
s_nop 1
v_permlane16_swap_b32 v8, v9
v_max_f32 v8, v8, v9
v_mov_b32 v9, v8
s_nop 1
v_permlane32_swap_b32 v8, v9
v_max_f32 v8, v8, v9
ds_write_b32 v7, v8
s_waitcnt lgkmcnt(0)
s_barrier
s_cmp_ge_u32 s54, 4
s_cbranch_scc1 L_fx_99
s_mul_i32 s64, s53, 43
s_lshr_b32 s64, s64, 8
s_mul_i32 s65, s64, 6
s_sub_u32 s65, s53, s65
s_lshl_b32 s65, s65, 3
s_add_u32 s65, s65, s52
s_cmp_ge_u32 s65, 43
s_cselect_b32 s65, 0x8000, s65
s_cmp_eq_u32 s64, 3
s_cbranch_scc1 L_fa_100
v_mul_u32_u24 v6, 2752, v0
s_lshl_b32 s65, s65, 6
s_cmp_eq_u32 s64, 1
s_cselect_b32 s66, 0, 704512
s_add_u32 s65, s65, s66
s_cmp_eq_u32 s64, 0
s_cbranch_scc1 L_fb_101
buffer_load_dword v245, v6, s[36:39], s65 offen
s_branch L_fx_99
L_fb_101:
buffer_load_dword v245, v6, s[32:35], s65 offen
s_branch L_fx_99
L_fa_100:
v_lshlrev_b32 v6, 7, v0
s_lshl_b32 s65, s65, 15
buffer_load_dword v245, v6, s[40:43], s65 offen
L_fx_99:
s_cmp_lg_u32 s60, s55
s_cbranch_scc1 L_lp_102
L_lq_103:
ds_read_b128 v[8:11], v227
ds_read_b128 v[12:15], v227 offset:16
s_waitcnt lgkmcnt(1)
v_max3_f32 v8, v8, v9, v10
s_waitcnt lgkmcnt(0)
v_max3_f32 v12, v12, v13, v14
v_max3_f32 v8, v8, v11, v15
v_max_f32 v5, v8, v12
v_sub_f32 v24, v24, v5
v_sub_f32 v25, v25, v5
v_sub_f32 v26, v26, v5
v_sub_f32 v27, v27, v5
v_exp_f32 v24, v24
v_exp_f32 v25, v25
v_exp_f32 v26, v26
v_exp_f32 v27, v27
v_cvt_pk_bf16_f32 v8, v24, v25
v_cvt_pk_bf16_f32 v9, v26, v27
v_add_f32 v10, v24, v25
v_add_f32 v11, v26, v27
ds_write_b64 v229, v[8:9]
v_add_f32 v10, v10, v11
v_mov_b32 v11, v10
s_nop 1
v_permlane16_swap_b32 v10, v11
v_add_f32 v10, v10, v11
v_mov_b32 v11, v10
s_nop 1
v_permlane32_swap_b32 v10, v11
v_add_f32 v10, v10, v11
ds_write_b32 v7, v10 offset:512
s_waitcnt lgkmcnt(0)
s_barrier
s_movk_i32 s67, 2048
buffer_store_dword v4, v233, s[4:7], s67 offen sc1
ds_read_b128 v[24:27], v227 offset:512
ds_read_b128 v[28:31], v227 offset:528
ds_read_b128 v[8:11], v230
ds_read_b128 v[12:15], v230 offset:64
v_lshlrev_b32 v7, 2, v2
s_lshl_b32 s64, s54, 6
s_add_u32 s64, s64, 153088
v_add_u32 v7, s64, v7
s_waitcnt lgkmcnt(1)
v_mfma_f32_16x16x32_bf16 v[16:19], v[8:11], v[96:99], 0
v_mfma_f32_16x16x32_bf16 v[20:23], v[8:11], v[100:103], 0
v_add_f32 v24, v24, v25
v_add_f32 v26, v26, v27
v_add_f32 v28, v28, v29
v_add_f32 v30, v30, v31
v_add_f32 v24, v24, v26
v_add_f32 v28, v28, v30
v_add_f32 v6, v24, v28
v_mfma_f32_16x16x32_bf16 v[24:27], v[8:11], v[104:107], 0
v_mfma_f32_16x16x32_bf16 v[28:31], v[8:11], v[108:111], 0
ds_read_b128 v[8:11], v230 offset:128
s_waitcnt lgkmcnt(1)
v_mfma_f32_16x16x32_bf16 v[16:19], v[12:15], v[112:115], v[16:19]
v_mfma_f32_16x16x32_bf16 v[20:23], v[12:15], v[116:119], v[20:23]
v_mfma_f32_16x16x32_bf16 v[24:27], v[12:15], v[120:123], v[24:27]
v_mfma_f32_16x16x32_bf16 v[28:31], v[12:15], v[124:127], v[28:31]
ds_read_b128 v[12:15], v230 offset:192
ds_write_b32 v7, v6
s_cmp_lg_u32 s54, 0
s_cbranch_scc1 L_k_104
v_log_f32 v6, v6
v_mov_b32 v7, v4
s_mov_b32 s64, 32768
v_add_f32 v6, v6, v5
s_mov_b32 exec_hi, 0
buffer_store_dwordx2 v[6:7], v232, s[4:7], s64 offen sc1
s_mov_b64 exec, -1
L_k_104:
s_waitcnt lgkmcnt(2)
v_mfma_f32_16x16x32_bf16 v[16:19], v[8:11], v[128:131], v[16:19]
v_mfma_f32_16x16x32_bf16 v[20:23], v[8:11], v[132:135], v[20:23]
v_mfma_f32_16x16x32_bf16 v[24:27], v[8:11], v[136:139], v[24:27]
v_mfma_f32_16x16x32_bf16 v[28:31], v[8:11], v[140:143], v[28:31]
ds_read_b128 v[8:11], v228
s_waitcnt lgkmcnt(2)
v_mfma_f32_16x16x32_bf16 v[16:19], v[12:15], v[144:147], v[16:19]
v_mfma_f32_16x16x32_bf16 v[20:23], v[12:15], v[148:151], v[20:23]
v_mfma_f32_16x16x32_bf16 v[24:27], v[12:15], v[152:155], v[24:27]
v_mfma_f32_16x16x32_bf16 v[28:31], v[12:15], v[156:159], v[28:31]
s_waitcnt lgkmcnt(0)
v_rcp_f32 v8, v8
v_rcp_f32 v9, v9
v_rcp_f32 v10, v10
v_rcp_f32 v11, v11
s_mov_b32 s64, 4194304
v_mul_f32 v16, v16, v8
v_mul_f32 v20, v20, v8
v_mul_f32 v24, v24, v8
v_mul_f32 v28, v28, v8
v_cvt_pk_bf16_f32 v12, v16, v20
v_bfi_b32 v12, s56, v247, v12
v_cvt_pk_bf16_f32 v13, v24, v28
v_bfi_b32 v13, s56, v248, v13
buffer_store_dwordx2 v[12:13], v231, s[4:7], s64 offen sc1
s_mov_b32 s64, 4325376
v_mul_f32 v17, v17, v9
v_mul_f32 v21, v21, v9
v_mul_f32 v25, v25, v9
v_mul_f32 v29, v29, v9
v_cvt_pk_bf16_f32 v14, v17, v21
v_bfi_b32 v14, s56, v247, v14
v_cvt_pk_bf16_f32 v15, v25, v29
v_bfi_b32 v15, s56, v248, v15
buffer_store_dwordx2 v[14:15], v231, s[4:7], s64 offen sc1
s_mov_b32 s64, 4456448
v_mul_f32 v18, v18, v10
v_mul_f32 v22, v22, v10
v_mul_f32 v26, v26, v10
v_mul_f32 v30, v30, v10
v_cvt_pk_bf16_f32 v12, v18, v22
v_bfi_b32 v12, s56, v247, v12
v_cvt_pk_bf16_f32 v13, v26, v30
v_bfi_b32 v13, s56, v248, v13
buffer_store_dwordx2 v[12:13], v231, s[4:7], s64 offen sc1
s_mov_b32 s64, 4587520
v_mul_f32 v19, v19, v11
v_mul_f32 v23, v23, v11
v_mul_f32 v27, v27, v11
v_mul_f32 v31, v31, v11
v_cvt_pk_bf16_f32 v14, v19, v23
v_bfi_b32 v14, s56, v247, v14
v_cvt_pk_bf16_f32 v15, v27, v31
v_bfi_b32 v15, s56, v248, v15
buffer_store_dwordx2 v[14:15], v231, s[4:7], s64 offen sc1
s_barrier
s_add_u32 s63, s53, 10
s_cmp_lt_u32 s63, 16
s_cbranch_scc1 L_fy_106
s_cmp_ge_u32 s63, 24
s_cbranch_scc1 L_fy_106
s_cmp_ge_u32 s54, 4
s_cbranch_scc1 L_fx_107
s_mul_i32 s64, s63, 43
s_lshr_b32 s64, s64, 8
s_mul_i32 s65, s64, 6
s_sub_u32 s65, s63, s65
s_lshl_b32 s65, s65, 3
s_add_u32 s65, s65, s52
s_cmp_ge_u32 s65, 43
s_cselect_b32 s65, 0x8000, s65
s_cmp_eq_u32 s64, 3
s_cbranch_scc1 L_fa_108
v_mul_u32_u24 v6, 2752, v0
s_lshl_b32 s65, s65, 6
s_cmp_eq_u32 s64, 1
s_cselect_b32 s66, 0, 704512
s_add_u32 s65, s65, s66
s_cmp_eq_u32 s64, 0
s_cbranch_scc1 L_fb_109
buffer_load_dword v255, v6, s[36:39], s65 offen
s_branch L_fx_107
L_fb_109:
buffer_load_dword v255, v6, s[32:35], s65 offen
s_branch L_fx_107
L_fa_108:
v_lshlrev_b32 v6, 7, v0
s_lshl_b32 s65, s65, 15
buffer_load_dword v255, v6, s[40:43], s65 offen
L_fx_107:
L_fy_106:
s_cmp_lg_u32 s54, 7
s_cbranch_scc1 L_rt_110
s_getpc_b64 s[72:73]
L_pc2:
s_sub_u32 s72, s72, L_pc2-interleave_layers__compressed_kv_cla__glu_gated_geglu__decode_kernel
s_subb_u32 s73, s73, 0
s_lshl_b32 s64, s53, 11
v_lshlrev_b32 v6, 5, v1
v_add_u32 v6, s64, v6
v_min_u32 v6, L_code_end-interleave_layers__compressed_kv_cla__glu_gated_geglu__decode_kernel-4, v6
global_load_dword v255, v6, s[72:73] sc1
L_rt_110:
s_cmp_ge_u32 s77, 43
s_cbranch_scc1 L_nf_105
v_lshrrev_b32 v6, 2, v1
s_lshl_b32 s64, s54, 6
v_add_u32 v6, s64, v6
v_mul_u32_u24 v6, 2752, v6
v_and_b32 v15, 3, v1
v_lshl_add_u32 v6, v15, 4, v6
s_lshl_b32 s64, s77, 6
v_add_u32 v6, s64, v6
s_lshl_b32 s66, s54, 12
s_mov_b32 s64, 0
s_add_u32 m0, s66, 0
s_nop 0
buffer_load_dwordx4 v6, s[32:35], s64 offen lds
s_mov_b32 s64, 44032
s_add_u32 m0, s66, 1024
s_nop 0
buffer_load_dwordx4 v6, s[32:35], s64 offen lds
s_mov_b32 s64, 88064
s_add_u32 m0, s66, 2048
s_nop 0
buffer_load_dwordx4 v6, s[32:35], s64 offen lds
s_mov_b32 s64, 132096
s_add_u32 m0, s66, 3072
s_nop 0
buffer_load_dwordx4 v6, s[32:35], s64 offen lds
s_barrier
s_mov_b32 s64, 0
s_add_u32 m0, s66, 32768
s_nop 0
buffer_load_dwordx4 v6, s[36:39], s64 offen lds
s_mov_b32 s64, 44032
s_add_u32 m0, s66, 33792
s_nop 0
buffer_load_dwordx4 v6, s[36:39], s64 offen lds
s_mov_b32 s64, 88064
s_add_u32 m0, s66, 34816
s_nop 0
buffer_load_dwordx4 v6, s[36:39], s64 offen lds
s_mov_b32 s64, 132096
s_add_u32 m0, s66, 35840
s_nop 0
buffer_load_dwordx4 v6, s[36:39], s64 offen lds
s_barrier
v_lshrrev_b32 v6, 3, v1
v_lshlrev_b32 v6, 10, v6
v_and_b32 v7, 7, v1
v_lshl_add_u32 v6, v7, 4, v6
s_lshl_b32 s64, s77, 15
s_lshl_b32 s65, s54, 7
s_add_u32 s64, s64, s65
v_add_u32 v6, s64, v6
s_mov_b32 s64, 0
s_add_u32 m0, s66, 65536
s_nop 0
buffer_load_dwordx4 v6, s[40:43], s64 offen lds
s_mov_b32 s64, 8192
s_add_u32 m0, s66, 66560
s_nop 0
buffer_load_dwordx4 v6, s[40:43], s64 offen lds
s_mov_b32 s64, 16384
s_add_u32 m0, s66, 67584
s_nop 0
buffer_load_dwordx4 v6, s[40:43], s64 offen lds
s_mov_b32 s64, 24576
s_add_u32 m0, s66, 68608
s_nop 0
buffer_load_dwordx4 v6, s[40:43], s64 offen lds
v_lshlrev_b32 v7, 4, v1
v_lshlrev_b32 v11, 4, v3
v_mov_b32 v12, 160640
v_and_b32 v15, 3, v1
s_lshl_b32 s64, s54, 8
v_lshlrev_b32 v6, 11, v3
v_lshl_add_u32 v6, v2, 4, v6
v_add_u32 v235, s64, v6
v_bfe_u32 v10, v2, 2, 1
s_add_u32 s65, s64, 98304
v_lshlrev_b32 v6, 7, v10
v_add_u32 v6, s65, v6
v_add_u32 v9, v6, v11
v_lshrrev_b32 v8, 3, v2
v_lshl_add_u32 v6, v8, 6, v6
v_lshl_add_u32 v6, v15, 4, v6
v_lshl_add_u32 v236, v3, 2, v6
v_lshlrev_b32 v6, 7, v10
v_add_u32 v6, s65, v6
v_and_b32 v9, 1, v2
v_lshl_add_u32 v9, v9, 6, v11
v_add_u32 v9, v9, v6
v_and_b32 v16, 1, v3
v_lshl_add_u32 v6, v16, 6, v6
v_lshl_add_u32 v6, v8, 5, v6
v_lshrrev_b32 v16, 1, v15
v_lshl_add_u32 v6, v16, 4, v6
v_and_b32 v16, 1, v15
v_lshl_add_u32 v6, v16, 3, v6
v_lshrrev_b32 v16, 1, v3
v_lshl_add_u32 v236, v16, 2, v6
v_mov_b32 v6, 160512
v_lshrrev_b32 v16, 1, v2
v_cmp_eq_u32 vcc, 4, v16
s_nop 1
v_cndmask_b32 v237, v9, v6, vcc
s_mul_i32 s65, s54, 768
s_add_u32 s65, s65, 101376
v_add_u32 v6, s65, v7
v_lshlrev_b32 v9, 2, v1
v_cmp_gt_u32 vcc, 48, v1
s_nop 1
v_cndmask_b32 v238, v12, v6, vcc
v_and_b32 v8, 1, v3
v_lshlrev_b32 v8, 3, v8
v_lshl_add_u32 v8, v2, 4, v8
v_lshrrev_b32 v6, 5, v1
v_lshl_add_u32 v8, v6, 8, v8
v_add_u32 v239, 101376, v8
v_lshlrev_b32 v6, 6, v6
v_add_u32 v241, 107520, v6
v_lshrrev_b32 v6, 3, v1
v_lshlrev_b32 v6, 5, v6
s_lshl_b32 s65, s54, 2
s_add_u32 s65, s65, 107520
v_add_u32 v6, s65, v6
s_mov_b32 vcc_lo, 0x01100101
s_mov_b32 vcc_hi, 0
v_cndmask_b32 v240, v12, v6, vcc
s_lshl_b32 s65, s54, 3
s_add_u32 s65, s65, 107520
v_lshlrev_b32 v6, 4, v1
v_add_u32 v6, s65, v6
s_mov_b32 vcc_lo, 0x11
v_cndmask_b32 v240, v12, v6, vcc
v_and_b32 v6, 1, v2
v_mul_u32_u24 v250, 0xaaaa, v6
v_add_u32 v250, 0x4444, v250
s_lshl_b32 s65, s54, 7
s_add_u32 s65, s65, 100352
v_lshlrev_b32 v6, 1, v1
v_add_u32 v242, s65, v6
v_lshl_add_u32 v6, v10, 6, v11
v_add_u32 v243, s65, v6
s_and_b32 s65, s77, 60
s_add_u32 s65, s65, s77
s_lshl_b32 s65, s65, 11
s_lshl_b32 s64, s54, 9
s_add_u32 s65, s65, s64
v_add_u32 v244, s65, v9
v_add_u32 v235, s100, v235
v_bfe_u32 v14, v1, 2, 2
v_and_b32 v6, 1, v14
v_lshlrev_b32 v6, 4, v6
v_lshl_add_u32 v6, v3, 2, v6
v_lshrrev_b32 v7, 1, v14
v_add_u32 v6, v6, v7
v_lshlrev_b32 v6, 6, v6
v_lshl_add_u32 v6, v15, 3, v6
v_add_u32 v6, s66, v6
v_lshl_add_u32 v7, v3, 3, v14
v_lshlrev_b32 v7, 7, v7
v_lshl_add_u32 v7, v15, 3, v7
s_and_b32 s64, s54, 3
s_lshl_b32 s64, s64, 13
s_add_u32 s64, s64, 65536
v_add_u32 v7, s64, v7
s_waitcnt vmcnt(4)
ds_read_b64_tr_b16 v[160:161], v6 offset:0
ds_read_b64_tr_b16 v[162:163], v6 offset:128
ds_read_b64_tr_b16 v[164:165], v6 offset:2048
ds_read_b64_tr_b16 v[166:167], v6 offset:2176
ds_read_b64_tr_b16 v[176:177], v6 offset:32
ds_read_b64_tr_b16 v[178:179], v6 offset:160
ds_read_b64_tr_b16 v[180:181], v6 offset:2080
ds_read_b64_tr_b16 v[182:183], v6 offset:2208
ds_read_b64_tr_b16 v[168:169], v6 offset:32768
ds_read_b64_tr_b16 v[170:171], v6 offset:32896
ds_read_b64_tr_b16 v[172:173], v6 offset:34816
ds_read_b64_tr_b16 v[174:175], v6 offset:34944
ds_read_b64_tr_b16 v[184:185], v6 offset:32800
ds_read_b64_tr_b16 v[186:187], v6 offset:32928
s_waitcnt lgkmcnt(8)
ds_read_b64_tr_b16 v[188:189], v6 offset:34848
ds_read_b64_tr_b16 v[190:191], v6 offset:34976
s_waitcnt vmcnt(0)
s_barrier
ds_read_b64_tr_b16 v[192:193], v7 offset:0
ds_read_b64_tr_b16 v[194:195], v7 offset:512
ds_read_b64_tr_b16 v[196:197], v7 offset:32
ds_read_b64_tr_b16 v[198:199], v7 offset:544
s_waitcnt lgkmcnt(8)
ds_read_b64_tr_b16 v[200:201], v7 offset:64
ds_read_b64_tr_b16 v[202:203], v7 offset:576
ds_read_b64_tr_b16 v[204:205], v7 offset:96
ds_read_b64_tr_b16 v[206:207], v7 offset:608
ds_read_b64_tr_b16 v[208:209], v7 offset:4096
ds_read_b64_tr_b16 v[210:211], v7 offset:4608
s_waitcnt lgkmcnt(8)
ds_read_b64_tr_b16 v[212:213], v7 offset:4128
ds_read_b64_tr_b16 v[214:215], v7 offset:4640
ds_read_b64_tr_b16 v[216:217], v7 offset:4160
ds_read_b64_tr_b16 v[218:219], v7 offset:4672
ds_read_b64_tr_b16 v[220:221], v7 offset:4192
ds_read_b64_tr_b16 v[222:223], v7 offset:4704
s_waitcnt lgkmcnt(0)
s_branch L_ov_111
L_rs_112:
s_sub_u32 s59, s59, 1
s_cbranch_scc1 L_end
s_sleep 1
s_branch L_in_113
L_ov_111:
s_mov_b32 s64, 360448
s_mov_b32 s65, 376832
s_mov_b32 s66, 0xfffe
s_cmp_lg_u32 s54, 0
s_cbranch_scc1 L_cb_115
s_movk_i32 s63, 4096
s_mov_b64 exec, 0xff
s_waitcnt vmcnt(0)
buffer_load_dword v24, v234, s[4:7], s63 offen sc1
s_nop 15
L_can_114:
s_sub_u32 s59, s59, 1
s_cbranch_scc1 L_end
buffer_load_dword v25, v234, s[4:7], s63 offen sc1
s_waitcnt vmcnt(1)
v_cmp_ne_u32 vcc, v24, v4
s_cbranch_vccz L_co_116
buffer_load_dword v24, v234, s[4:7], s63 offen sc1
s_waitcnt vmcnt(1)
v_cmp_ne_u32 vcc, v25, v4
s_cbranch_vccnz L_can_114
L_co_116:
s_mov_b64 exec, -1
s_sleep 4
L_cb_115:
s_barrier
L_in_113:
buffer_load_dwordx4 v[8:11], v235, s[4:7], s64 offen sc1
buffer_load_dwordx4 v[12:15], v235, s[4:7], s65 offen sc1
s_waitcnt vmcnt(0)
v_xor_b32 v6, v251, v8
v_bitop3_b32 v6, v9, v252, v6 bitop3:0xbe
v_bitop3_b32 v6, v10, v253, v6 bitop3:0xbe
v_bitop3_b32 v6, v11, v254, v6 bitop3:0xbe
v_bitop3_b32 v6, v12, v251, v6 bitop3:0xbe
v_bitop3_b32 v6, v13, v252, v6 bitop3:0xbe
v_bitop3_b32 v6, v14, v253, v6 bitop3:0xbe
v_bitop3_b32 v6, v15, v254, v6 bitop3:0xbe
v_and_b32 v6, s56, v6
v_cmp_ne_u32 vcc, 0, v6
s_cbranch_vccnz L_rs_112
v_and_b32_sdwa v16, s66, v8 dst_sel:WORD_1 dst_unused:UNUSED_PAD src0_sel:WORD_0 src1_sel:WORD_0
v_and_b32 v17, 0xfffe0000, v8
v_and_b32_sdwa v24, s66, v12 dst_sel:WORD_1 dst_unused:UNUSED_PAD src0_sel:WORD_0 src1_sel:WORD_0
v_and_b32 v25, 0xfffe0000, v12
v_and_b32_sdwa v18, s66, v9 dst_sel:WORD_1 dst_unused:UNUSED_PAD src0_sel:WORD_0 src1_sel:WORD_0
v_and_b32 v19, 0xfffe0000, v9
v_and_b32_sdwa v26, s66, v13 dst_sel:WORD_1 dst_unused:UNUSED_PAD src0_sel:WORD_0 src1_sel:WORD_0
v_and_b32 v27, 0xfffe0000, v13
v_and_b32_sdwa v20, s66, v10 dst_sel:WORD_1 dst_unused:UNUSED_PAD src0_sel:WORD_0 src1_sel:WORD_0
v_and_b32 v21, 0xfffe0000, v10
v_and_b32_sdwa v28, s66, v14 dst_sel:WORD_1 dst_unused:UNUSED_PAD src0_sel:WORD_0 src1_sel:WORD_0
v_and_b32 v29, 0xfffe0000, v14
v_and_b32_sdwa v22, s66, v11 dst_sel:WORD_1 dst_unused:UNUSED_PAD src0_sel:WORD_0 src1_sel:WORD_0
v_and_b32 v23, 0xfffe0000, v11
v_and_b32_sdwa v30, s66, v15 dst_sel:WORD_1 dst_unused:UNUSED_PAD src0_sel:WORD_0 src1_sel:WORD_0
v_and_b32 v31, 0xfffe0000, v15
v_pk_add_f32 v[16:17], v[16:17], v[24:25]
v_pk_add_f32 v[18:19], v[18:19], v[26:27]
v_pk_add_f32 v[20:21], v[20:21], v[28:29]
v_pk_add_f32 v[22:23], v[22:23], v[30:31]
s_nop 0
v_permlane32_swap_b32 v16, v20
v_permlane32_swap_b32 v17, v21
v_permlane32_swap_b32 v18, v22
v_permlane32_swap_b32 v19, v23
v_pk_add_f32 v[16:17], v[16:17], v[20:21]
v_pk_add_f32 v[18:19], v[18:19], v[22:23]
s_nop 1
v_permlane16_swap_b32 v16, v18
v_permlane16_swap_b32 v17, v19
v_pk_add_f32 v[16:17], v[16:17], v[18:19]
v_cvt_pk_bf16_f32 v6, v16, v17
ds_write_b32 v236, v6
ds_read_b128 v[8:11], v237
v_lshlrev_b32 v12, 16, v6
v_and_b32 v13, 0xffff0000, v6
v_add_f32 v7, v12, v13
v_mul_f32 v6, v12, v12
v_fmac_f32 v6, v13, v13
v_mov_b32 v16, 0
v_mov_b32 v17, 0
v_mov_b32 v20, 0
v_mov_b32 v21, 0
v_mov_b32 v24, 0
v_mov_b32 v25, 0
v_mov_b32 v28, 0
v_mov_b32 v29, 0
s_waitcnt lgkmcnt(0)
v_smfmac_f32_16x16x64_bf16 v[16:19], v[8:11], v[160:167], v250
v_smfmac_f32_16x16x64_bf16 v[20:23], v[8:11], v[168:175], v250
v_smfmac_f32_16x16x64_bf16 v[24:27], v[8:11], v[176:183], v250
v_smfmac_f32_16x16x64_bf16 v[28:31], v[8:11], v[184:191], v250
v_add_f32_dpp v6, v6, v6 quad_perm:[1,0,3,2] row_mask:0xf bank_mask:0xf
v_add_f32_dpp v7, v7, v7 quad_perm:[1,0,3,2] row_mask:0xf bank_mask:0xf
s_nop 0
v_add_f32_dpp v6, v6, v6 quad_perm:[2,3,0,1] row_mask:0xf bank_mask:0xf
v_add_f32_dpp v7, v7, v7 quad_perm:[2,3,0,1] row_mask:0xf bank_mask:0xf
s_nop 0
v_add_f32_dpp v6, v6, v6 row_ror:8 row_mask:0xf bank_mask:0xf
v_add_f32_dpp v7, v7, v7 row_ror:8 row_mask:0xf bank_mask:0xf
v_mov_b32 v12, v6
v_mov_b32 v13, v7
s_nop 0
v_permlane16_swap_b32 v6, v12
v_permlane16_swap_b32 v7, v13
v_add_f32 v6, v6, v12
v_add_f32 v7, v7, v13
v_mov_b32 v12, v6
v_mov_b32 v13, v7
s_nop 0
v_permlane32_swap_b32 v6, v12
v_permlane32_swap_b32 v7, v13
v_add_f32 v6, v6, v12
v_add_f32 v7, v7, v13
v_add_f32 v16, v16, v17
v_add_f32 v17, v20, v21
v_add_f32 v18, v24, v25
v_add_f32 v19, v28, v29
ds_write_b128 v238, v[16:19]
ds_write_b64 v240, v[6:7]
s_waitcnt lgkmcnt(0)
s_barrier
s_cmp_ge_u32 s54, 4
s_cbranch_scc0 L_bs_117
s_branch L_nf_105
L_bs_117:
s_movk_i32 s67, 6144
buffer_store_dword v4, v233, s[4:7], s67 offen sc1
v_lshrrev_b32 v6, 5, v1
v_lshlrev_b32 v6, 8, v6
v_sub_u32 v6, v239, v6
ds_read_b64 v[8:9], v6 offset:512
ds_read_b64 v[10:11], v6 offset:1280
ds_read_b64 v[12:13], v6 offset:2048
ds_read_b64 v[14:15], v6 offset:2816
ds_read_b64 v[16:17], v6 offset:3584
ds_read_b64 v[18:19], v6 offset:4352
ds_read_b64 v[20:21], v6 offset:5120
ds_read_b64 v[22:23], v6 offset:5888
s_waitcnt lgkmcnt(0)
v_pk_add_f32 v[8:9], v[8:9], v[10:11]
v_pk_add_f32 v[12:13], v[12:13], v[14:15]
v_pk_add_f32 v[16:17], v[16:17], v[18:19]
v_pk_add_f32 v[20:21], v[20:21], v[22:23]
v_pk_add_f32 v[8:9], v[8:9], v[12:13]
v_pk_add_f32 v[16:17], v[16:17], v[20:21]
v_add_f32 v245, v8, v16
v_add_f32 v246, v9, v17
ds_read_b128 v[24:27], v241
ds_read_b128 v[28:31], v241 offset:16
ds_read_b128 v[8:11], v241 offset:32
ds_read_b128 v[12:15], v241 offset:48
ds_read_b64 v[16:17], v239 offset:0
ds_read_b64 v[18:19], v239 offset:768
ds_read_b64 v[20:21], v239 offset:1536
ds_read_b64 v[22:23], v239 offset:2304
s_waitcnt lgkmcnt(6)
v_pk_add_f32 v[24:25], v[24:25], v[26:27]
v_pk_add_f32 v[28:29], v[28:29], v[30:31]
v_pk_add_f32 v[24:25], v[24:25], v[28:29]
s_waitcnt lgkmcnt(4)
v_pk_add_f32 v[8:9], v[8:9], v[10:11]
v_pk_add_f32 v[12:13], v[12:13], v[14:15]
v_pk_add_f32 v[6:7], v[24:25], v[8:9]
ds_read_b64 v[24:25], v239 offset:3072
ds_read_b64 v[26:27], v239 offset:3840
ds_read_b64 v[28:29], v239 offset:4608
ds_read_b64 v[30:31], v239 offset:5376
v_pk_add_f32 v[6:7], v[6:7], v[12:13]
v_mul_f32 v7, 0x3b000000, v7
v_mov_b32 v12, 0x3727c5ac
v_fmac_f32 v12, 0x3b000000, v6
v_fma_f32 v12, -v7, v7, v12
v_max_f32 v12, 0x3727c5ac, v12
v_rsq_f32 v12, v12
s_waitcnt lgkmcnt(4)
v_pk_add_f32 v[16:17], v[16:17], v[18:19]
v_pk_add_f32 v[20:21], v[20:21], v[22:23]
v_pk_add_f32 v[16:17], v[16:17], v[20:21]
s_waitcnt lgkmcnt(0)
v_pk_add_f32 v[24:25], v[24:25], v[26:27]
v_pk_add_f32 v[28:29], v[28:29], v[30:31]
v_pk_add_f32 v[16:17], v[16:17], v[24:25]
v_pk_add_f32 v[8:9], v[16:17], v[28:29]
v_fma_f32 v8, -v7, v245, v8
v_fma_f32 v9, -v7, v246, v9
v_mul_f32 v8, v8, v12
v_mul_f32 v9, v9, v12
v_mul_f32 v10, v8, v8
v_mov_b32 v11, 0xc0135761
v_fmac_f32 v11, 0xbdd2d3e8, v10
v_mul_f32 v10, v11, v8
v_exp_f32 v10, v10
v_mul_f32 v8, v8, v9
v_add_f32 v10, 1.0, v10
v_rcp_f32 v10, v10
s_mov_b32 s64, 425984
s_mov_b32 s65, 434176
v_mul_f32 v8, v8, v10
v_cvt_pk_bf16_f32 v8, v8, v8
ds_write_b16 v242, v8
ds_read_b128 v[8:11], v243
s_waitcnt lgkmcnt(0)
v_mfma_f32_16x16x32_bf16 v[12:15], v[8:11], v[192:195], 0
v_mfma_f32_16x16x32_bf16 v[14:17], v[8:11], v[196:199], 0
v_mfma_f32_16x16x32_bf16 v[16:19], v[8:11], v[200:203], 0
v_mfma_f32_16x16x32_bf16 v[18:21], v[8:11], v[204:207], 0
v_mfma_f32_16x16x32_bf16 v[20:23], v[8:11], v[208:211], 0
v_mfma_f32_16x16x32_bf16 v[22:25], v[8:11], v[212:215], 0
v_mfma_f32_16x16x32_bf16 v[24:27], v[8:11], v[216:219], 0
v_mfma_f32_16x16x32_bf16 v[26:29], v[8:11], v[220:223], 0
s_nop 1
v_cvt_pk_bf16_f32 v8, v12, v14
v_bfi_b32 v8, s56, v249, v8
v_cvt_pk_bf16_f32 v9, v16, v18
v_bfi_b32 v9, s56, v249, v9
s_nop 1
v_permlane32_swap_b32 v8, v9
buffer_store_dword v8, v244, s[4:7], s64 offen offset:0 sc1
buffer_store_dword v8, v244, s[4:7], s65 offen offset:0 sc1
v_cvt_pk_bf16_f32 v10, v20, v22
v_bfi_b32 v10, s56, v249, v10
v_cvt_pk_bf16_f32 v11, v24, v26
v_bfi_b32 v11, s56, v249, v11
s_nop 1
v_permlane32_swap_b32 v10, v11
buffer_store_dword v10, v244, s[4:7], s64 offen offset:256 sc1
buffer_store_dword v10, v244, s[4:7], s65 offen offset:256 sc1
L_nf_105:
s_branch L_pg_118
.p2align 12
L_pg_118:
s_branch L_ov_120
L_rs_121:
s_sub_u32 s59, s59, 1
s_cbranch_scc1 L_end
s_sleep 1
s_branch L_in_122
L_ov_120:
s_cmp_lg_u32 s54, 0
s_cbranch_scc1 L_cb_124
s_movk_i32 s63, 1024
s_mov_b64 exec, 0xff
s_waitcnt vmcnt(0)
buffer_load_dword v24, v234, s[4:7], s63 offen sc1
s_nop 15
L_can_123:
s_sub_u32 s59, s59, 1
s_cbranch_scc1 L_end
buffer_load_dword v25, v234, s[4:7], s63 offen sc1
s_waitcnt vmcnt(1)
v_cmp_ne_u32 vcc, v24, v4
s_cbranch_vccz L_co_125
buffer_load_dword v24, v234, s[4:7], s63 offen sc1
s_waitcnt vmcnt(1)
v_cmp_ne_u32 vcc, v25, v4
s_cbranch_vccnz L_can_123
L_co_125:
s_mov_b64 exec, -1
s_sleep 2
L_cb_124:
s_barrier
s_mov_b32 s64, 229376
L_in_122:
buffer_load_dwordx4 v[8:11], v224, s[4:7], s64 offen sc1
buffer_load_dwordx4 v[12:15], v224, s[4:7], s64 offen offset:1024 sc1
s_waitcnt vmcnt(0)
v_xor_b32 v8, v251, v8
v_xor_b32 v9, v252, v9
v_xor_b32 v10, v253, v10
v_xor_b32 v11, v254, v11
v_xor_b32 v12, v251, v12
v_xor_b32 v13, v252, v13
v_xor_b32 v14, v253, v14
v_xor_b32 v15, v254, v15
ds_write_b128 v225, v[8:11]
ds_write_b128 v225, v[12:15] offset:1056
v_or3_b32 v6, v8, v9, v10
v_or3_b32 v6, v11, v12, v6
v_or3_b32 v6, v13, v14, v6
v_bitop3_b32 v6, v15, v6, s56 bitop3:0xa8
v_cmp_ne_u32 vcc, 0, v6
s_cbranch_vccnz L_rs_121
s_waitcnt lgkmcnt(0)
s_barrier
ds_read_b128 v[8:11], v226 offset:0
ds_read_b128 v[12:15], v226 offset:64
ds_read_b128 v[16:19], v226 offset:128
ds_read_b128 v[20:23], v226 offset:192
ds_read_b128 v[28:31], v226 offset:256
s_waitcnt lgkmcnt(4)
v_mfma_f32_16x16x32_bf16 v[24:27], v[32:35], v[8:11], 0
ds_read_b128 v[8:11], v226 offset:320
s_waitcnt lgkmcnt(4)
v_mfma_f32_16x16x32_bf16 v[24:27], v[36:39], v[12:15], v[24:27]
ds_read_b128 v[12:15], v226 offset:384
s_waitcnt lgkmcnt(4)
v_mfma_f32_16x16x32_bf16 v[24:27], v[40:43], v[16:19], v[24:27]
ds_read_b128 v[16:19], v226 offset:448
s_waitcnt lgkmcnt(4)
v_mfma_f32_16x16x32_bf16 v[24:27], v[44:47], v[20:23], v[24:27]
ds_read_b128 v[20:23], v226 offset:512
s_waitcnt lgkmcnt(4)
v_mfma_f32_16x16x32_bf16 v[24:27], v[48:51], v[28:31], v[24:27]
ds_read_b128 v[28:31], v226 offset:576
s_waitcnt lgkmcnt(4)
v_mfma_f32_16x16x32_bf16 v[24:27], v[52:55], v[8:11], v[24:27]
ds_read_b128 v[8:11], v226 offset:640
s_waitcnt lgkmcnt(4)
v_mfma_f32_16x16x32_bf16 v[24:27], v[56:59], v[12:15], v[24:27]
ds_read_b128 v[12:15], v226 offset:704
s_waitcnt lgkmcnt(4)
v_mfma_f32_16x16x32_bf16 v[24:27], v[60:63], v[16:19], v[24:27]
ds_read_b128 v[16:19], v226 offset:768
s_waitcnt lgkmcnt(4)
v_mfma_f32_16x16x32_bf16 v[24:27], v[64:67], v[20:23], v[24:27]
ds_read_b128 v[20:23], v226 offset:832
s_waitcnt lgkmcnt(4)
v_mfma_f32_16x16x32_bf16 v[24:27], v[68:71], v[28:31], v[24:27]
ds_read_b128 v[28:31], v226 offset:896
s_waitcnt lgkmcnt(4)
v_mfma_f32_16x16x32_bf16 v[24:27], v[72:75], v[8:11], v[24:27]
ds_read_b128 v[8:11], v226 offset:960
s_waitcnt lgkmcnt(4)
v_mfma_f32_16x16x32_bf16 v[24:27], v[76:79], v[12:15], v[24:27]
s_waitcnt lgkmcnt(3)
v_mfma_f32_16x16x32_bf16 v[24:27], v[80:83], v[16:19], v[24:27]
s_waitcnt lgkmcnt(2)
v_mfma_f32_16x16x32_bf16 v[24:27], v[84:87], v[20:23], v[24:27]
s_waitcnt lgkmcnt(1)
v_mfma_f32_16x16x32_bf16 v[24:27], v[88:91], v[28:31], v[24:27]
s_waitcnt lgkmcnt(0)
v_mfma_f32_16x16x32_bf16 v[24:27], v[92:95], v[8:11], v[24:27]
s_lshl_b32 s64, s54, 2
v_add_u32 v7, s64, v227
s_nop 5
v_max3_f32 v8, v24, v25, v26
v_max_f32 v8, v8, v27
v_mov_b32 v9, v8
s_nop 1
v_permlane16_swap_b32 v8, v9
v_max_f32 v8, v8, v9
v_mov_b32 v9, v8
s_nop 1
v_permlane32_swap_b32 v8, v9
v_max_f32 v8, v8, v9
ds_write_b32 v7, v8
s_waitcnt lgkmcnt(0)
s_barrier
ds_read_b128 v[8:11], v227
ds_read_b128 v[12:15], v227 offset:16
s_waitcnt lgkmcnt(1)
v_max3_f32 v8, v8, v9, v10
s_waitcnt lgkmcnt(0)
v_max3_f32 v12, v12, v13, v14
v_max3_f32 v8, v8, v11, v15
v_max_f32 v5, v8, v12
v_sub_f32 v24, v24, v5
v_sub_f32 v25, v25, v5
v_sub_f32 v26, v26, v5
v_sub_f32 v27, v27, v5
v_exp_f32 v24, v24
v_exp_f32 v25, v25
v_exp_f32 v26, v26
v_exp_f32 v27, v27
v_cvt_pk_bf16_f32 v8, v24, v25
v_cvt_pk_bf16_f32 v9, v26, v27
v_add_f32 v10, v24, v25
v_add_f32 v11, v26, v27
ds_write_b64 v229, v[8:9]
v_add_f32 v10, v10, v11
v_mov_b32 v11, v10
s_nop 1
v_permlane16_swap_b32 v10, v11
v_add_f32 v10, v10, v11
v_mov_b32 v11, v10
s_nop 1
v_permlane32_swap_b32 v10, v11
v_add_f32 v10, v10, v11
ds_write_b32 v7, v10 offset:512
s_waitcnt lgkmcnt(0)
s_barrier
s_movk_i32 s67, 3072
buffer_store_dword v4, v233, s[4:7], s67 offen sc1
ds_read_b128 v[24:27], v227 offset:512
ds_read_b128 v[28:31], v227 offset:528
ds_read_b128 v[8:11], v230
ds_read_b128 v[12:15], v230 offset:64
v_lshlrev_b32 v7, 2, v2
s_lshl_b32 s64, s54, 6
s_add_u32 s64, s64, 153088
v_add_u32 v7, s64, v7
s_waitcnt lgkmcnt(1)
v_mfma_f32_16x16x32_bf16 v[16:19], v[8:11], v[96:99], 0
v_mfma_f32_16x16x32_bf16 v[20:23], v[8:11], v[100:103], 0
v_add_f32 v24, v24, v25
v_add_f32 v26, v26, v27
v_add_f32 v28, v28, v29
v_add_f32 v30, v30, v31
v_add_f32 v24, v24, v26
v_add_f32 v28, v28, v30
v_add_f32 v6, v24, v28
v_mfma_f32_16x16x32_bf16 v[24:27], v[8:11], v[104:107], 0
v_mfma_f32_16x16x32_bf16 v[28:31], v[8:11], v[108:111], 0
ds_read_b128 v[8:11], v230 offset:128
s_waitcnt lgkmcnt(1)
v_mfma_f32_16x16x32_bf16 v[16:19], v[12:15], v[112:115], v[16:19]
v_mfma_f32_16x16x32_bf16 v[20:23], v[12:15], v[116:119], v[20:23]
v_mfma_f32_16x16x32_bf16 v[24:27], v[12:15], v[120:123], v[24:27]
v_mfma_f32_16x16x32_bf16 v[28:31], v[12:15], v[124:127], v[28:31]
ds_read_b128 v[12:15], v230 offset:192
ds_write_b32 v7, v6
s_cmp_lg_u32 s54, 0
s_cbranch_scc1 L_k_126
v_log_f32 v6, v6
v_mov_b32 v7, v4
s_mov_b32 s64, 65536
v_add_f32 v6, v6, v5
s_mov_b32 exec_hi, 0
buffer_store_dwordx2 v[6:7], v232, s[4:7], s64 offen sc1
s_mov_b64 exec, -1
L_k_126:
s_waitcnt lgkmcnt(2)
v_mfma_f32_16x16x32_bf16 v[16:19], v[8:11], v[128:131], v[16:19]
v_mfma_f32_16x16x32_bf16 v[20:23], v[8:11], v[132:135], v[20:23]
v_mfma_f32_16x16x32_bf16 v[24:27], v[8:11], v[136:139], v[24:27]
v_mfma_f32_16x16x32_bf16 v[28:31], v[8:11], v[140:143], v[28:31]
ds_read_b128 v[8:11], v228
s_waitcnt lgkmcnt(2)
v_mfma_f32_16x16x32_bf16 v[16:19], v[12:15], v[144:147], v[16:19]
v_mfma_f32_16x16x32_bf16 v[20:23], v[12:15], v[148:151], v[20:23]
v_mfma_f32_16x16x32_bf16 v[24:27], v[12:15], v[152:155], v[24:27]
v_mfma_f32_16x16x32_bf16 v[28:31], v[12:15], v[156:159], v[28:31]
s_waitcnt lgkmcnt(0)
v_rcp_f32 v8, v8
v_rcp_f32 v9, v9
v_rcp_f32 v10, v10
v_rcp_f32 v11, v11
s_mov_b32 s64, 8388608
v_mul_f32 v16, v16, v8
v_mul_f32 v20, v20, v8
v_mul_f32 v24, v24, v8
v_mul_f32 v28, v28, v8
v_cvt_pk_bf16_f32 v12, v16, v20
v_bfi_b32 v12, s56, v247, v12
v_cvt_pk_bf16_f32 v13, v24, v28
v_bfi_b32 v13, s56, v248, v13
buffer_store_dwordx2 v[12:13], v231, s[4:7], s64 offen sc1
s_mov_b32 s64, 8519680
v_mul_f32 v17, v17, v9
v_mul_f32 v21, v21, v9
v_mul_f32 v25, v25, v9
v_mul_f32 v29, v29, v9
v_cvt_pk_bf16_f32 v14, v17, v21
v_bfi_b32 v14, s56, v247, v14
v_cvt_pk_bf16_f32 v15, v25, v29
v_bfi_b32 v15, s56, v248, v15
buffer_store_dwordx2 v[14:15], v231, s[4:7], s64 offen sc1
s_mov_b32 s64, 8650752
v_mul_f32 v18, v18, v10
v_mul_f32 v22, v22, v10
v_mul_f32 v26, v26, v10
v_mul_f32 v30, v30, v10
v_cvt_pk_bf16_f32 v12, v18, v22
v_bfi_b32 v12, s56, v247, v12
v_cvt_pk_bf16_f32 v13, v26, v30
v_bfi_b32 v13, s56, v248, v13
buffer_store_dwordx2 v[12:13], v231, s[4:7], s64 offen sc1
s_mov_b32 s64, 8781824
v_mul_f32 v19, v19, v11
v_mul_f32 v23, v23, v11
v_mul_f32 v27, v27, v11
v_mul_f32 v31, v31, v11
v_cvt_pk_bf16_f32 v14, v19, v23
v_bfi_b32 v14, s56, v247, v14
v_cvt_pk_bf16_f32 v15, v27, v31
v_bfi_b32 v15, s56, v248, v15
buffer_store_dwordx2 v[14:15], v231, s[4:7], s64 offen sc1
s_cmp_ge_u32 s77, 43
s_cbranch_scc1 L_nf_127
s_branch L_ov_128
L_rs_129:
s_sub_u32 s59, s59, 1
s_cbranch_scc1 L_end
s_sleep 1
s_branch L_in_130
L_ov_128:
s_mov_b32 s64, 393216
s_mov_b32 s65, 409600
s_mov_b32 s66, 0xfffe
s_cmp_lg_u32 s54, 0
s_cbranch_scc1 L_cb_132
s_movk_i32 s63, 5120
s_mov_b64 exec, 0xff
s_waitcnt vmcnt(0)
buffer_load_dword v24, v234, s[4:7], s63 offen sc1
s_nop 15
L_can_131:
s_sub_u32 s59, s59, 1
s_cbranch_scc1 L_end
buffer_load_dword v25, v234, s[4:7], s63 offen sc1
s_waitcnt vmcnt(1)
v_cmp_ne_u32 vcc, v24, v4
s_cbranch_vccz L_co_133
buffer_load_dword v24, v234, s[4:7], s63 offen sc1
s_waitcnt vmcnt(1)
v_cmp_ne_u32 vcc, v25, v4
s_cbranch_vccnz L_can_131
L_co_133:
s_mov_b64 exec, -1
s_sleep 5
L_cb_132:
s_barrier
L_in_130:
buffer_load_dwordx4 v[8:11], v235, s[4:7], s64 offen sc1
buffer_load_dwordx4 v[12:15], v235, s[4:7], s65 offen sc1
s_waitcnt vmcnt(0)
v_xor_b32 v6, v251, v8
v_bitop3_b32 v6, v9, v252, v6 bitop3:0xbe
v_bitop3_b32 v6, v10, v253, v6 bitop3:0xbe
v_bitop3_b32 v6, v11, v254, v6 bitop3:0xbe
v_bitop3_b32 v6, v12, v251, v6 bitop3:0xbe
v_bitop3_b32 v6, v13, v252, v6 bitop3:0xbe
v_bitop3_b32 v6, v14, v253, v6 bitop3:0xbe
v_bitop3_b32 v6, v15, v254, v6 bitop3:0xbe
v_and_b32 v6, s56, v6
v_cmp_ne_u32 vcc, 0, v6
s_cbranch_vccnz L_rs_129
v_and_b32_sdwa v16, s66, v8 dst_sel:WORD_1 dst_unused:UNUSED_PAD src0_sel:WORD_0 src1_sel:WORD_0
v_and_b32 v17, 0xfffe0000, v8
v_and_b32_sdwa v24, s66, v12 dst_sel:WORD_1 dst_unused:UNUSED_PAD src0_sel:WORD_0 src1_sel:WORD_0
v_and_b32 v25, 0xfffe0000, v12
v_and_b32_sdwa v18, s66, v9 dst_sel:WORD_1 dst_unused:UNUSED_PAD src0_sel:WORD_0 src1_sel:WORD_0
v_and_b32 v19, 0xfffe0000, v9
v_and_b32_sdwa v26, s66, v13 dst_sel:WORD_1 dst_unused:UNUSED_PAD src0_sel:WORD_0 src1_sel:WORD_0
v_and_b32 v27, 0xfffe0000, v13
v_and_b32_sdwa v20, s66, v10 dst_sel:WORD_1 dst_unused:UNUSED_PAD src0_sel:WORD_0 src1_sel:WORD_0
v_and_b32 v21, 0xfffe0000, v10
v_and_b32_sdwa v28, s66, v14 dst_sel:WORD_1 dst_unused:UNUSED_PAD src0_sel:WORD_0 src1_sel:WORD_0
v_and_b32 v29, 0xfffe0000, v14
v_and_b32_sdwa v22, s66, v11 dst_sel:WORD_1 dst_unused:UNUSED_PAD src0_sel:WORD_0 src1_sel:WORD_0
v_and_b32 v23, 0xfffe0000, v11
v_and_b32_sdwa v30, s66, v15 dst_sel:WORD_1 dst_unused:UNUSED_PAD src0_sel:WORD_0 src1_sel:WORD_0
v_and_b32 v31, 0xfffe0000, v15
v_pk_add_f32 v[16:17], v[16:17], v[24:25]
v_pk_add_f32 v[18:19], v[18:19], v[26:27]
v_pk_add_f32 v[20:21], v[20:21], v[28:29]
v_pk_add_f32 v[22:23], v[22:23], v[30:31]
s_nop 0
v_permlane32_swap_b32 v16, v20
v_permlane32_swap_b32 v17, v21
v_permlane32_swap_b32 v18, v22
v_permlane32_swap_b32 v19, v23
v_pk_add_f32 v[16:17], v[16:17], v[20:21]
v_pk_add_f32 v[18:19], v[18:19], v[22:23]
s_nop 1
v_permlane16_swap_b32 v16, v18
v_permlane16_swap_b32 v17, v19
v_pk_add_f32 v[16:17], v[16:17], v[18:19]
v_cvt_pk_bf16_f32 v6, v16, v17
ds_write_b32 v236, v6
ds_read_b128 v[8:11], v237
v_lshlrev_b32 v12, 16, v6
v_and_b32 v13, 0xffff0000, v6
v_add_f32 v7, v12, v13
v_mul_f32 v6, v12, v12
v_fmac_f32 v6, v13, v13
v_mov_b32 v16, 0
v_mov_b32 v17, 0
v_mov_b32 v20, 0
v_mov_b32 v21, 0
v_mov_b32 v24, 0
v_mov_b32 v25, 0
v_mov_b32 v28, 0
v_mov_b32 v29, 0
s_waitcnt lgkmcnt(0)
v_smfmac_f32_16x16x64_bf16 v[16:19], v[8:11], v[160:167], v250
v_smfmac_f32_16x16x64_bf16 v[20:23], v[8:11], v[168:175], v250
v_smfmac_f32_16x16x64_bf16 v[24:27], v[8:11], v[176:183], v250
v_smfmac_f32_16x16x64_bf16 v[28:31], v[8:11], v[184:191], v250
v_add_f32_dpp v6, v6, v6 quad_perm:[1,0,3,2] row_mask:0xf bank_mask:0xf
v_add_f32_dpp v7, v7, v7 quad_perm:[1,0,3,2] row_mask:0xf bank_mask:0xf
s_nop 0
v_add_f32_dpp v6, v6, v6 quad_perm:[2,3,0,1] row_mask:0xf bank_mask:0xf
v_add_f32_dpp v7, v7, v7 quad_perm:[2,3,0,1] row_mask:0xf bank_mask:0xf
s_nop 0
v_add_f32_dpp v6, v6, v6 row_ror:8 row_mask:0xf bank_mask:0xf
v_add_f32_dpp v7, v7, v7 row_ror:8 row_mask:0xf bank_mask:0xf
v_mov_b32 v12, v6
v_mov_b32 v13, v7
s_nop 0
v_permlane16_swap_b32 v6, v12
v_permlane16_swap_b32 v7, v13
v_add_f32 v6, v6, v12
v_add_f32 v7, v7, v13
v_mov_b32 v12, v6
v_mov_b32 v13, v7
s_nop 0
v_permlane32_swap_b32 v6, v12
v_permlane32_swap_b32 v7, v13
v_add_f32 v6, v6, v12
v_add_f32 v7, v7, v13
v_add_f32 v16, v16, v17
v_add_f32 v17, v20, v21
v_add_f32 v18, v24, v25
v_add_f32 v19, v28, v29
ds_write_b128 v238, v[16:19]
ds_write_b64 v240, v[6:7]
s_waitcnt lgkmcnt(0)
s_barrier
s_cmp_ge_u32 s54, 4
s_cbranch_scc0 L_bs_134
s_branch L_nf_127
L_bs_134:
s_movk_i32 s67, 7168
buffer_store_dword v4, v233, s[4:7], s67 offen sc1
ds_read_b128 v[24:27], v241
ds_read_b128 v[28:31], v241 offset:16
ds_read_b128 v[8:11], v241 offset:32
ds_read_b128 v[12:15], v241 offset:48
ds_read_b64 v[16:17], v239 offset:0
ds_read_b64 v[18:19], v239 offset:768
ds_read_b64 v[20:21], v239 offset:1536
ds_read_b64 v[22:23], v239 offset:2304
s_waitcnt lgkmcnt(6)
v_pk_add_f32 v[24:25], v[24:25], v[26:27]
v_pk_add_f32 v[28:29], v[28:29], v[30:31]
v_pk_add_f32 v[24:25], v[24:25], v[28:29]
s_waitcnt lgkmcnt(4)
v_pk_add_f32 v[8:9], v[8:9], v[10:11]
v_pk_add_f32 v[12:13], v[12:13], v[14:15]
v_pk_add_f32 v[6:7], v[24:25], v[8:9]
ds_read_b64 v[24:25], v239 offset:3072
ds_read_b64 v[26:27], v239 offset:3840
ds_read_b64 v[28:29], v239 offset:4608
ds_read_b64 v[30:31], v239 offset:5376
v_pk_add_f32 v[6:7], v[6:7], v[12:13]
v_mul_f32 v7, 0x3b000000, v7
v_mov_b32 v12, 0x3727c5ac
v_fmac_f32 v12, 0x3b000000, v6
v_fma_f32 v12, -v7, v7, v12
v_max_f32 v12, 0x3727c5ac, v12
v_rsq_f32 v12, v12
s_waitcnt lgkmcnt(4)
v_pk_add_f32 v[16:17], v[16:17], v[18:19]
v_pk_add_f32 v[20:21], v[20:21], v[22:23]
v_pk_add_f32 v[16:17], v[16:17], v[20:21]
s_waitcnt lgkmcnt(0)
v_pk_add_f32 v[24:25], v[24:25], v[26:27]
v_pk_add_f32 v[28:29], v[28:29], v[30:31]
v_pk_add_f32 v[16:17], v[16:17], v[24:25]
v_pk_add_f32 v[8:9], v[16:17], v[28:29]
v_fma_f32 v8, -v7, v245, v8
v_fma_f32 v9, -v7, v246, v9
v_mul_f32 v8, v8, v12
v_mul_f32 v9, v9, v12
v_mul_f32 v10, v8, v8
v_mov_b32 v11, 0xc0135761
v_fmac_f32 v11, 0xbdd2d3e8, v10
v_mul_f32 v10, v11, v8
v_exp_f32 v10, v10
v_mul_f32 v8, v8, v9
v_add_f32 v10, 1.0, v10
v_rcp_f32 v10, v10
s_mov_b32 s64, 606208
s_mov_b32 s65, 614400
v_mul_f32 v8, v8, v10
v_cvt_pk_bf16_f32 v8, v8, v8
ds_write_b16 v242, v8
ds_read_b128 v[8:11], v243
s_waitcnt lgkmcnt(0)
v_mfma_f32_16x16x32_bf16 v[12:15], v[8:11], v[192:195], 0
v_mfma_f32_16x16x32_bf16 v[14:17], v[8:11], v[196:199], 0
v_mfma_f32_16x16x32_bf16 v[16:19], v[8:11], v[200:203], 0
v_mfma_f32_16x16x32_bf16 v[18:21], v[8:11], v[204:207], 0
v_mfma_f32_16x16x32_bf16 v[20:23], v[8:11], v[208:211], 0
v_mfma_f32_16x16x32_bf16 v[22:25], v[8:11], v[212:215], 0
v_mfma_f32_16x16x32_bf16 v[24:27], v[8:11], v[216:219], 0
v_mfma_f32_16x16x32_bf16 v[26:29], v[8:11], v[220:223], 0
s_nop 1
v_cvt_pk_bf16_f32 v8, v12, v14
v_bfi_b32 v8, s56, v249, v8
v_cvt_pk_bf16_f32 v9, v16, v18
v_bfi_b32 v9, s56, v249, v9
s_nop 1
v_permlane32_swap_b32 v8, v9
buffer_store_dword v8, v244, s[4:7], s64 offen offset:0 sc1
buffer_store_dword v8, v244, s[4:7], s65 offen offset:0 sc1
v_cvt_pk_bf16_f32 v10, v20, v22
v_bfi_b32 v10, s56, v249, v10
v_cvt_pk_bf16_f32 v11, v24, v26
v_bfi_b32 v11, s56, v249, v11
s_nop 1
v_permlane32_swap_b32 v10, v11
buffer_store_dword v10, v244, s[4:7], s64 offen offset:256 sc1
buffer_store_dword v10, v244, s[4:7], s65 offen offset:256 sc1
L_nf_127:
s_endpgm
L_i0r_11:
s_sub_u32 s59, s59, 1
s_cbranch_scc1 L_end
s_sub_u32 s63, s63, 1
s_cmp_lg_u32 s63, 0
s_cbranch_scc1 L_i0p_10
s_cmp_ge_u32 s54, 4
s_cbranch_scc1 L_i0p_10
s_mov_b64 exec, -1
buffer_store_dwordx4 v[232:235], v176, s[4:7], 0 offen sc1
buffer_store_dwordx4 v[236:239], v207, s[4:7], 0 offen sc1
buffer_store_dwordx2 v[228:229], v181, s[4:7], s66 offen sc1
L_i0p_10:
s_mov_b64 exec, 0xffff
buffer_load_dwordx4 v[16:19], v180, s[4:7], s66 offen sc1
s_waitcnt vmcnt(0)
v_xor_b32 v7, v4, v17
v_bitop3_b32 v7, v19, v4, v7 bitop3:0xbe
v_cmp_ne_u32 vcc, 0, v7
s_cbranch_vccnz L_i0r_11
s_branch L_i0m_12
L_rs_17:
s_cmp_ge_u32 s54, 4
s_cbranch_scc1 L_rt_18
buffer_store_dwordx4 v[232:235], v176, s[4:7], 0 offen sc1
buffer_store_dwordx4 v[236:239], v207, s[4:7], 0 offen sc1
buffer_store_dwordx2 v[228:229], v181, s[4:7], s66 offen sc1
s_branch L_rt_18
L_pw_22:
s_sub_u32 s59, s59, 1
s_cbranch_scc1 L_end
s_sleep 2
v_mov_b32 v20, 128
buffer_load_dwordx2 v[20:21], v20, s[4:7], 0 offen sc1
s_branch L_px_23
L_sc_37:
s_nop 4
v_add_f32 v16, v16, v17
v_add_f32 v20, v20, v21
v_cvt_pk_bf16_f32 v8, v16, v20
v_bfi_b32 v8, s56, v109, v8
buffer_store_dword v8, v194, s[4:7], s65 offen sc1
s_branch L_sd_38
L_sc_51:
s_nop 5
v_bfi_b32 v8, s57, v4, v244
v_bfi_b32 v9, s57, v208, v245
v_bfi_b32 v10, s57, v209, v246
v_bfi_b32 v11, s57, v210, v247
buffer_store_dwordx4 v[8:11], v175, s[4:7], 0 offen sc1
s_branch L_sd_52
L_sc_72:
s_nop 4
v_add_f32 v16, v16, v17
v_add_f32 v20, v20, v21
v_cvt_pk_bf16_f32 v8, v16, v20
v_bfi_b32 v8, s56, v109, v8
buffer_store_dword v8, v194, s[4:7], s65 offen sc1
s_branch L_sd_73
L_pt_96:
s_sub_u32 s66, s66, 1
s_cbranch_scc1 L_pq_95
s_sleep 2
v_mov_b32 v20, 128
buffer_load_dwordx2 v[20:21], v20, s[4:7], 0 offen sc1
s_branch L_pu_97
L_s1_92:
s_sub_u32 s59, s59, 1
s_cbranch_scc1 L_end
s_sleep 1
buffer_load_dwordx4 v[8:11], v224, s[4:7], s64 offen sc1
buffer_load_dwordx4 v[12:15], v224, s[4:7], s64 offen offset:1024 sc1
s_waitcnt vmcnt(0)
s_branch L_in_98
L_lp_102:
s_sub_u32 s59, s59, 1
s_cbranch_scc1 L_end
v_mov_b32 v20, 128
buffer_load_dwordx2 v[20:21], v20, s[4:7], 0 offen sc1
s_waitcnt vmcnt(0)
v_readfirstlane_b32 s60, v20
v_readfirstlane_b32 s101, v21
s_cmp_lg_u32 s60, s55
s_cbranch_scc1 L_lp_102
s_lshr_b32 s64, s101, 3
s_lshr_b32 s65, s61, 2
s_xor_b32 s64, s64, s65
s_and_b32 s64, s64, 1
s_lshl_b32 s100, s64, 13
v_add_u32 v224, s100, v224
v_add_u32 v234, s100, v234
s_lshl_b32 s64, s69, 2
s_add_u32 s64, s64, s101
v_add_u32 v6, s64, v3
v_lshlrev_b32 v6, 1, v6
v_xor_b32 v6, s101, v6
v_and_b32 v6, 8, v6
v_lshl_add_u32 v231, v6, 10, v231
s_branch L_lq_103
L_end:
s_endpgm
L_code_end:
.section .rodata,"a"
.p2align 6
.amdhsa_kernel interleave_layers__compressed_kv_cla__glu_gated_geglu__decode_kernel
  .amdhsa_next_free_vgpr 256
  .amdhsa_next_free_sgpr 102
  .amdhsa_accum_offset 256
  .amdhsa_group_segment_fixed_size 0
  .amdhsa_kernarg_size 104
  .amdhsa_user_sgpr_count 2
  .amdhsa_user_sgpr_kernarg_segment_ptr 1
  .amdhsa_system_sgpr_workgroup_id_x 1
.end_amdhsa_kernel
```
